```python
import torch

def _softmax(x, axis=-1):
    return torch.softmax(x, dim=axis)
def _gelu(x):
    return torch.nn.functional.gelu(x, approximate="tanh")
def _silu(x):
    return torch.nn.functional.silu(x)
def _sigmoid(x):
    return torch.sigmoid(x)
def _layernorm(x, axis=-1, eps=1e-5):
    m = x.mean(dim=axis, keepdim=True)
    v = x.var(dim=axis, keepdim=True, unbiased=False)
    return (x - m) / torch.sqrt(v + eps)
def _scatter_add(tgt, idx, src, axis=0):
    return tgt.clone().index_add_(axis, idx, src)
def _segment_sum(src, seg, n):
    out = torch.zeros((n,) + src.shape[1:], dtype=src.dtype)
    return out.index_add_(0, seg, src)
def _pad(x, pw):
    flat = tuple(v for pair in reversed(pw) for v in pair)
    return torch.nn.functional.pad(x, flat)

kernel_name = 'gather_scatter__cheap_equivariant_egnn__graph'

def setup_inputs():

    _w = (lambda a: (lambda t: t.to(torch.bfloat16) if t.is_floating_point() else t)(torch.as_tensor(a)))
    N, deg, D, De = 10000, 64, 64, max(16, 1)
    E = N * deg
    return {
        "h": _w((lambda *s: torch.randn(*s, dtype=torch.bfloat16) * 0.1)(N, D)),
        "pos": _w((lambda *s: torch.randn(*s, dtype=torch.bfloat16) * 0.8)(N, 3)),
        "e_attr": _w((lambda *s: torch.randn(*s, dtype=torch.bfloat16) * 0.8)(E, De)),
        "src": _w((lambda lo, hi, *s: torch.randint(lo, hi, s))(0, N, E).to(torch.int64)),
        "dst": _w((lambda lo, hi, *s: torch.randint(lo, hi, s))(0, N, E).to(torch.int64)),
        "w_e": _w(0.1 * (lambda *s: torch.randn(*s, dtype=torch.bfloat16) * 0.8)(2 * D + 1 + De, D)),
        "w_x": _w(0.1 * (lambda *s: torch.randn(*s, dtype=torch.bfloat16) * 0.1)(D, 1)),
        "w_h": _w(0.1 * (lambda *s: torch.randn(*s, dtype=torch.bfloat16) * 0.1)(2 * D, D)),
    }

def reference(h, pos, e_attr, src, dst, w_e, w_x, w_h):
    N, D = h.shape[0], h.shape[1]
    diff = pos[dst] - pos[src]
    dist2 = torch.sum(diff * diff, axis=-1, keepdims=True)
    e_in = torch.concatenate([h[dst], h[src], dist2, e_attr], axis=-1)
    m_ij = _silu(e_in @ w_e)
    coord_scale = m_ij @ w_x
    pos_new = pos + _segment_sum(diff * coord_scale, dst, N)
    m_i = _segment_sum(m_ij, dst, N)
    h_new = h + _silu(torch.concatenate([h, m_i], axis=-1) @ w_h)
    return h_new, pos_new
```

```asm
; @launch kernel=egnn_bin_kernel grid=(250,1,1) block=(512,1,1) lds=1280
; @launch kernel=gather_scatter__cheap_equivariant_egnn__graph_kernel grid=(250,1,1) block=(1024,1,1) lds=110592
.amdgcn_target "amdgcn-amd-amdhsa--gfx950"
.text
.globl egnn_bin_kernel
.p2align 8
.type egnn_bin_kernel,@function
egnn_bin_kernel:
    s_cmp_ge_u32 s2, 250
    s_cbranch_scc1 A_done
    s_load_dwordx2 s[4:5], s[0:1], 8
    s_load_dwordx4 s[8:11], s[0:1], 24
    s_load_dwordx2 s[6:7], s[0:1], 80
    s_waitcnt lgkmcnt(0)
    s_mov_b32 s12, s8
    s_and_b32 s13, s9, 0xffff
    s_mov_b32 s14, 2560000
    s_mov_b32 s15, 0x00020000
    s_mov_b32 s16, s10
    s_and_b32 s17, s11, 0xffff
    s_mov_b32 s18, 2560000
    s_mov_b32 s19, 0x00020000
    s_mov_b32 s20, s6
    s_and_b32 s21, s7, 0xffff
    s_mov_b32 s22, 268435456
    s_mov_b32 s23, 0x00020000
    s_mov_b32 s24, s4
    s_and_b32 s25, s5, 0xffff
    s_mov_b32 s26, 60000
    s_mov_b32 s27, 0x00020000
    s_mul_i32 s3, s2, 2560
    v_lshlrev_b32 v1, 2, v0
    v_mov_b32 v2, 0
    v_cmp_gt_u32 vcc, 0x140, v0
    s_and_saveexec_b64 s[28:29], vcc
    ds_write_b32 v1, v2
    s_mov_b64 exec, s[28:29]
    v_add_u32 v3, s3, v0
    v_lshlrev_b32 v4, 2, v3
    s_movk_i32 s34, 0
    buffer_load_dword v10, v4, s[16:19], s34 offen
    buffer_load_dword v18, v4, s[12:15], s34 offen
    s_movk_i32 s34, 2048
    buffer_load_dword v11, v4, s[16:19], s34 offen
    buffer_load_dword v19, v4, s[12:15], s34 offen
    s_movk_i32 s34, 4096
    buffer_load_dword v12, v4, s[16:19], s34 offen
    buffer_load_dword v20, v4, s[12:15], s34 offen
    s_movk_i32 s34, 6144
    buffer_load_dword v13, v4, s[16:19], s34 offen
    buffer_load_dword v21, v4, s[12:15], s34 offen
    s_movk_i32 s34, 8192
    buffer_load_dword v14, v4, s[16:19], s34 offen
    buffer_load_dword v22, v4, s[12:15], s34 offen
    s_waitcnt lgkmcnt(0)
    s_barrier
    s_mov_b32 s30, 52429
    s_mul_i32 s31, s2, 256
    s_mul_i32 s33, s2, 20480
    s_add_u32 s33, s33, 19922944
    s_waitcnt vmcnt(8)
    v_mul_u32_u24 v5, s30, v10
    v_lshrrev_b32 v5, 21, v5
    v_lshlrev_b32 v6, 2, v5
    v_mov_b32 v7, 1
    ds_add_rtn_u32 v8, v6, v7
    v_lshlrev_b32 v9, 16, v10
    v_or_b32 v27, v9, v18
    v_add_u32 v26, 0, v3
    s_waitcnt lgkmcnt(0)
    v_mul_u32_u24 v9, 64000, v5
    v_lshl_add_u32 v9, v8, 3, v9
    v_add_u32 v9, s31, v9
    v_cmp_gt_u32 vcc, 32, v8
    s_and_saveexec_b64 s[28:29], vcc
    buffer_store_dwordx2 v[26:27], v9, s[20:23], 0 offen
    s_andn2_b64 exec, s[28:29], exec
    s_cbranch_execz A_skip0
    v_mov_b32 v6, 1024
    ds_add_rtn_u32 v8, v6, v7
    s_waitcnt lgkmcnt(0)
    v_lshl_add_u32 v9, v8, 3, s33
    buffer_store_dwordx2 v[26:27], v9, s[20:23], 0 offen
A_skip0:
    s_mov_b64 exec, s[28:29]
    s_waitcnt vmcnt(6)
    v_mul_u32_u24 v5, s30, v11
    v_lshrrev_b32 v5, 21, v5
    v_lshlrev_b32 v6, 2, v5
    v_mov_b32 v7, 1
    ds_add_rtn_u32 v8, v6, v7
    v_lshlrev_b32 v9, 16, v11
    v_or_b32 v27, v9, v19
    v_add_u32 v26, 512, v3
    s_waitcnt lgkmcnt(0)
    v_mul_u32_u24 v9, 64000, v5
    v_lshl_add_u32 v9, v8, 3, v9
    v_add_u32 v9, s31, v9
    v_cmp_gt_u32 vcc, 32, v8
    s_and_saveexec_b64 s[28:29], vcc
    buffer_store_dwordx2 v[26:27], v9, s[20:23], 0 offen
    s_andn2_b64 exec, s[28:29], exec
    s_cbranch_execz A_skip1
    v_mov_b32 v6, 1024
    ds_add_rtn_u32 v8, v6, v7
    s_waitcnt lgkmcnt(0)
    v_lshl_add_u32 v9, v8, 3, s33
    buffer_store_dwordx2 v[26:27], v9, s[20:23], 0 offen
A_skip1:
    s_mov_b64 exec, s[28:29]
    s_waitcnt vmcnt(4)
    v_mul_u32_u24 v5, s30, v12
    v_lshrrev_b32 v5, 21, v5
    v_lshlrev_b32 v6, 2, v5
    v_mov_b32 v7, 1
    ds_add_rtn_u32 v8, v6, v7
    v_lshlrev_b32 v9, 16, v12
    v_or_b32 v27, v9, v20
    v_add_u32 v26, 1024, v3
    s_waitcnt lgkmcnt(0)
    v_mul_u32_u24 v9, 64000, v5
    v_lshl_add_u32 v9, v8, 3, v9
    v_add_u32 v9, s31, v9
    v_cmp_gt_u32 vcc, 32, v8
    s_and_saveexec_b64 s[28:29], vcc
    buffer_store_dwordx2 v[26:27], v9, s[20:23], 0 offen
    s_andn2_b64 exec, s[28:29], exec
    s_cbranch_execz A_skip2
    v_mov_b32 v6, 1024
    ds_add_rtn_u32 v8, v6, v7
    s_waitcnt lgkmcnt(0)
    v_lshl_add_u32 v9, v8, 3, s33
    buffer_store_dwordx2 v[26:27], v9, s[20:23], 0 offen
A_skip2:
    s_mov_b64 exec, s[28:29]
    s_waitcnt vmcnt(2)
    v_mul_u32_u24 v5, s30, v13
    v_lshrrev_b32 v5, 21, v5
    v_lshlrev_b32 v6, 2, v5
    v_mov_b32 v7, 1
    ds_add_rtn_u32 v8, v6, v7
    v_lshlrev_b32 v9, 16, v13
    v_or_b32 v27, v9, v21
    v_add_u32 v26, 1536, v3
    s_waitcnt lgkmcnt(0)
    v_mul_u32_u24 v9, 64000, v5
    v_lshl_add_u32 v9, v8, 3, v9
    v_add_u32 v9, s31, v9
    v_cmp_gt_u32 vcc, 32, v8
    s_and_saveexec_b64 s[28:29], vcc
    buffer_store_dwordx2 v[26:27], v9, s[20:23], 0 offen
    s_andn2_b64 exec, s[28:29], exec
    s_cbranch_execz A_skip3
    v_mov_b32 v6, 1024
    ds_add_rtn_u32 v8, v6, v7
    s_waitcnt lgkmcnt(0)
    v_lshl_add_u32 v9, v8, 3, s33
    buffer_store_dwordx2 v[26:27], v9, s[20:23], 0 offen
A_skip3:
    s_mov_b64 exec, s[28:29]
    s_waitcnt vmcnt(0)
    v_mul_u32_u24 v5, s30, v14
    v_lshrrev_b32 v5, 21, v5
    v_lshlrev_b32 v6, 2, v5
    v_mov_b32 v7, 1
    ds_add_rtn_u32 v8, v6, v7
    v_lshlrev_b32 v9, 16, v14
    v_or_b32 v27, v9, v22
    v_add_u32 v26, 2048, v3
    s_waitcnt lgkmcnt(0)
    v_mul_u32_u24 v9, 64000, v5
    v_lshl_add_u32 v9, v8, 3, v9
    v_add_u32 v9, s31, v9
    v_cmp_gt_u32 vcc, 32, v8
    s_and_saveexec_b64 s[28:29], vcc
    buffer_store_dwordx2 v[26:27], v9, s[20:23], 0 offen
    s_andn2_b64 exec, s[28:29], exec
    s_cbranch_execz A_skip4
    v_mov_b32 v6, 1024
    ds_add_rtn_u32 v8, v6, v7
    s_waitcnt lgkmcnt(0)
    v_lshl_add_u32 v9, v8, 3, s33
    buffer_store_dwordx2 v[26:27], v9, s[20:23], 0 offen
A_skip4:
    s_mov_b64 exec, s[28:29]
    s_waitcnt lgkmcnt(0)
    s_barrier
    v_cmp_gt_u32 vcc, 250, v0
    s_and_saveexec_b64 s[28:29], vcc
    ds_read_b32 v5, v1
    s_waitcnt lgkmcnt(0)
    v_min_u32 v5, 32, v5
    v_mul_u32_u24 v6, 1000, v0
    s_lshl_b32 s32, s2, 2
    s_add_u32 s32, s32, 16777216
    v_add_u32 v6, s32, v6
    buffer_store_dword v5, v6, s[20:23], 0 offen
    s_mov_b64 exec, s[28:29]
    v_cmp_eq_u32 vcc, 0, v0
    s_and_saveexec_b64 s[28:29], vcc
    v_mov_b32 v6, 1024
    ds_read_b32 v5, v6
    s_waitcnt lgkmcnt(0)
    s_lshl_b32 s32, s2, 2
    s_add_u32 s32, s32, 18874368
    v_mov_b32 v6, s32
    buffer_store_dword v5, v6, s[20:23], 0 offen
    s_mov_b64 exec, s[28:29]
    v_cmp_gt_u32 vcc, 40, v0
    s_and_saveexec_b64 s[28:29], vcc
    s_mul_i32 s32, s2, 40
    v_add_u32 v5, s32, v0
    v_mul_u32_u24 v6, 6, v5
    buffer_load_ushort v12, v6, s[24:27], 0 offen offset:0
    buffer_load_ushort v13, v6, s[24:27], 0 offen offset:2
    buffer_load_ushort v14, v6, s[24:27], 0 offen offset:4
    s_waitcnt vmcnt(0)
    v_lshlrev_b32 v12, 16, v12
    v_lshlrev_b32 v13, 16, v13
    v_lshlrev_b32 v14, 16, v14
    v_mov_b32 v15, 0
    v_lshlrev_b32 v6, 4, v5
    v_add_u32 v6, 17825792, v6
    buffer_store_dwordx4 v[12:15], v6, s[20:23], 0 offen
    s_mov_b64 exec, s[28:29]
    s_cmp_ge_u32 s2, 36
    s_cbranch_scc1 A_done
    v_cmp_gt_u32 vcc, 64, v0
    s_and_saveexec_b64 s[28:29], vcc
    s_cbranch_execz A_done
    s_load_dwordx2 s[36:37], s[0:1], 40
    s_load_dwordx2 s[38:39], s[0:1], 56
    s_waitcnt lgkmcnt(0)
    s_cmp_ge_u32 s2, 20
    s_cbranch_scc1 A_fh
    s_mov_b32 s40, s36
    s_and_b32 s41, s37, 0xffff
    s_mov_b32 s42, 18560
    s_mov_b32 s43, 0x00020000
    s_and_b32 s44, s2, 3
    s_lshr_b32 s45, s2, 2
    s_lshl_b32 s45, s45, 5
    s_add_u32 s45, s45, 64
    s_cmp_eq_u32 s45, 128
    s_cselect_b32 s45, 129, s45
    s_cmp_ge_u32 s2, 12
    s_cbranch_scc0 A_fgo
    s_sub_u32 s45, s45, 160
    s_branch A_fgo
A_fh:
    s_mov_b32 s40, s38
    s_and_b32 s41, s39, 0xffff
    s_mov_b32 s42, 16384
    s_mov_b32 s43, 0x00020000
    s_sub_u32 s46, s2, 20
    s_lshr_b32 s44, s46, 2
    s_and_b32 s45, s46, 3
    s_lshl_b32 s45, s45, 5
A_fgo:
    v_and_b32 v1, 15, v0
    v_lshrrev_b32 v2, 4, v0
    s_lshl_b32 s46, s45, 7
    s_lshl_b32 s47, s44, 5
    s_add_u32 s46, s46, s47
    v_lshlrev_b32 v5, 10, v2
    v_lshl_add_u32 v5, v1, 1, v5
    v_add_u32 v5, s46, v5
    buffer_load_ushort v10, v5, s[40:43], 0 offen offset:0
    buffer_load_ushort v11, v5, s[40:43], 0 offen offset:128
    buffer_load_ushort v12, v5, s[40:43], 0 offen offset:256
    buffer_load_ushort v13, v5, s[40:43], 0 offen offset:384
    buffer_load_ushort v14, v5, s[40:43], 0 offen offset:512
    buffer_load_ushort v15, v5, s[40:43], 0 offen offset:640
    buffer_load_ushort v16, v5, s[40:43], 0 offen offset:768
    buffer_load_ushort v17, v5, s[40:43], 0 offen offset:896
    s_cmp_eq_u32 s45, 129
    s_cbranch_scc0 A_fpk
    v_cmp_eq_u32 vcc, 2, v2
    s_and_b64 exec, exec, vcc
    v_lshlrev_b32 v5, 1, v1
    v_add_u32 v5, s47, v5
    v_add_u32 v5, 0x4000, v5
    buffer_load_ushort v10, v5, s[40:43], 0 offen
    s_mov_b64 exec, -1
A_fpk:
    s_waitcnt vmcnt(0)
    v_lshl_or_b32 v20, v11, 16, v10
    v_lshl_or_b32 v21, v13, 16, v12
    v_lshl_or_b32 v22, v15, 16, v14
    v_lshl_or_b32 v23, v17, 16, v16
    s_lshl_b32 s46, s2, 10
    s_add_u32 s46, s46, 25165824
    v_lshl_add_u32 v5, v0, 4, s46
    buffer_store_dwordx4 v[20:23], v5, s[20:23], 0 offen
A_done:
    s_endpgm
.globl gather_scatter__cheap_equivariant_egnn__graph_kernel
.p2align 8
.type gather_scatter__cheap_equivariant_egnn__graph_kernel,@function
gather_scatter__cheap_equivariant_egnn__graph_kernel:
    s_cmp_ge_u32 s2, 250
    s_cbranch_scc1 B_done
    s_load_dwordx2 s[4:5], s[0:1], 0
    s_load_dwordx2 s[6:7], s[0:1], 16
    s_load_dwordx4 s[8:11], s[0:1], 40
    s_load_dwordx4 s[12:15], s[0:1], 56
    s_load_dwordx2 s[16:17], s[0:1], 80
    s_load_dwordx2 s[18:19], s[0:1], 8
    s_waitcnt lgkmcnt(0)
    s_mov_b32 s20, s4
    s_and_b32 s21, s5, 0xffff
    s_mov_b32 s22, 1280000
    s_mov_b32 s23, 0x00020000
    s_mov_b32 s24, s6
    s_and_b32 s25, s7, 0xffff
    s_mov_b32 s26, 20480000
    s_mov_b32 s27, 0x00020000
    s_mov_b32 s32, s10
    s_and_b32 s33, s11, 0xffff
    s_mov_b32 s34, 128
    s_mov_b32 s35, 0x00020000
    s_mov_b32 s40, s14
    s_and_b32 s41, s15, 0xffff
    s_mov_b32 s42, 1340000
    s_mov_b32 s43, 0x00020000
    s_mov_b32 s44, s16
    s_and_b32 s45, s17, 0xffff
    s_mov_b32 s46, 268435456
    s_mov_b32 s47, 0x00020000
    s_mov_b32 s48, s18
    s_and_b32 s49, s19, 0xffff
    s_mov_b32 s50, 60000
    s_mov_b32 s51, 0x00020000
    v_and_b32 v1, 15, v0
    v_bfe_u32 v2, v0, 4, 2
    v_lshrrev_b32 v3, 6, v0
    s_nop 0
    v_readfirstlane_b32 s3, v3
    s_mul_i32 s52, s2, 40
    v_cmp_gt_u32 s[54:55], 2, v2
    v_cmp_gt_u32 s[94:95], 3, v2
    v_and_b32 v4, 63, v0
    v_lshlrev_b32 v4, 4, v4
    v_mov_b32 v8, 0
    v_lshlrev_b32 v5, 2, v0
    v_add_u32 v5, 13056, v5
    v_cmp_gt_u32 vcc, 23936, v5
    s_and_saveexec_b64 s[58:59], vcc
    ds_write_b32 v5, v8
    s_mov_b64 exec, s[58:59]
    v_lshlrev_b32 v5, 2, v0
    v_add_u32 v5, 17152, v5
    v_cmp_gt_u32 vcc, 23936, v5
    s_and_saveexec_b64 s[58:59], vcc
    ds_write_b32 v5, v8
    s_mov_b64 exec, s[58:59]
    v_lshlrev_b32 v5, 2, v0
    v_add_u32 v5, 21248, v5
    v_cmp_gt_u32 vcc, 23936, v5
    s_and_saveexec_b64 s[58:59], vcc
    ds_write_b32 v5, v8
    s_mov_b64 exec, s[58:59]
    v_mov_b32 v5, 24704
    ds_write_b32 v5, v8
    s_cmp_ge_u32 s3, 12
    s_cbranch_scc1 B_nowf
    s_lshl_b32 s53, s3, 10
    s_add_u32 s60, s53, 25165824
    buffer_load_dwordx4 v[12:15], v4, s[44:47], s60 offen
    v_add_u32 v5, s53, v4
    s_waitcnt vmcnt(0)
    ds_write_b128 v5, v[12:15] offset:24832
B_nowf:
    v_lshlrev_b32 v5, 3, v2
    buffer_load_ushort v96, v5, s[32:35], 0 offen offset:0
    buffer_load_ushort v97, v5, s[32:35], 0 offen offset:2
    buffer_load_ushort v98, v5, s[32:35], 0 offen offset:4
    buffer_load_ushort v99, v5, s[32:35], 0 offen offset:6
    v_lshlrev_b32 v5, 3, v2
    buffer_load_ushort v100, v5, s[32:35], 0 offen offset:32
    buffer_load_ushort v101, v5, s[32:35], 0 offen offset:34
    buffer_load_ushort v102, v5, s[32:35], 0 offen offset:36
    buffer_load_ushort v103, v5, s[32:35], 0 offen offset:38
    v_lshlrev_b32 v5, 3, v2
    buffer_load_ushort v104, v5, s[32:35], 0 offen offset:64
    buffer_load_ushort v105, v5, s[32:35], 0 offen offset:66
    buffer_load_ushort v106, v5, s[32:35], 0 offen offset:68
    buffer_load_ushort v107, v5, s[32:35], 0 offen offset:70
    v_lshlrev_b32 v5, 3, v2
    buffer_load_ushort v108, v5, s[32:35], 0 offen offset:96
    buffer_load_ushort v109, v5, s[32:35], 0 offen offset:98
    buffer_load_ushort v110, v5, s[32:35], 0 offen offset:100
    buffer_load_ushort v111, v5, s[32:35], 0 offen offset:102
    s_waitcnt lgkmcnt(0)
    s_barrier
    v_cmp_gt_u32 vcc, 250, v0
    s_and_saveexec_b64 s[58:59], vcc
    v_lshlrev_b32 v5, 2, v0
    v_add_u32 v5, 18874368, v5
    buffer_load_dword v6, v5, s[44:47], 0 offen
    s_waitcnt vmcnt(0)
    v_cmp_ne_u32 vcc, 0, v6
    s_and_b64 exec, exec, vcc
    v_mov_b32 v5, 24704
    v_mov_b32 v6, 1
    ds_write_b32 v5, v6
    s_mov_b64 exec, s[58:59]
    s_cmp_gt_u32 s3, 2
    s_cbranch_scc1 B_p1done
    s_mov_b32 s53, 25178112
    buffer_load_dwordx4 v[28:31], v4, s[44:47], s53 offen
    s_mov_b32 s53, 25179136
    buffer_load_dwordx4 v[32:35], v4, s[44:47], s53 offen
    s_mov_b32 s53, 25180160
    buffer_load_dwordx4 v[36:39], v4, s[44:47], s53 offen
    s_mov_b32 s53, 25181184
    buffer_load_dwordx4 v[40:43], v4, s[44:47], s53 offen
    s_mov_b32 s53, 25182208
    buffer_load_dwordx4 v[44:47], v4, s[44:47], s53 offen
    s_mov_b32 s53, 25183232
    buffer_load_dwordx4 v[48:51], v4, s[44:47], s53 offen
    s_mov_b32 s53, 25184256
    buffer_load_dwordx4 v[52:55], v4, s[44:47], s53 offen
    s_mov_b32 s53, 25185280
    buffer_load_dwordx4 v[56:59], v4, s[44:47], s53 offen
    s_lshl_b32 s60, s3, 4
    s_add_u32 s60, s60, s52
    v_add_u32 v6, s60, v1
    v_lshlrev_b32 v6, 7, v6
    v_lshl_add_u32 v6, v2, 4, v6
    buffer_load_dwordx4 v[60:63], v6, s[20:23], 0 offen
    buffer_load_dwordx4 v[64:67], v6, s[20:23], 0 offen offset:64
    s_waitcnt vmcnt(0)
    v_mfma_f32_16x16x32_bf16 v[12:15], v[28:31], v[60:63], 0
    v_mfma_f32_16x16x32_bf16 v[12:15], v[44:47], v[64:67], v[12:15]
    v_mfma_f32_16x16x32_bf16 v[16:19], v[32:35], v[60:63], 0
    v_mfma_f32_16x16x32_bf16 v[16:19], v[48:51], v[64:67], v[16:19]
    v_mfma_f32_16x16x32_bf16 v[20:23], v[36:39], v[60:63], 0
    v_mfma_f32_16x16x32_bf16 v[20:23], v[52:55], v[64:67], v[20:23]
    v_mfma_f32_16x16x32_bf16 v[24:27], v[40:43], v[60:63], 0
    v_mfma_f32_16x16x32_bf16 v[24:27], v[56:59], v[64:67], v[24:27]
    s_nop 15
    s_lshl_b32 s60, s3, 4
    v_add_u32 v6, s60, v1
    v_mul_u32_u24 v6, 272, v6
    v_lshl_add_u32 v6, v2, 4, v6
    ds_write_b128 v6, v[12:15] offset:0
    ds_write_b128 v6, v[16:19] offset:64
    ds_write_b128 v6, v[20:23] offset:128
    ds_write_b128 v6, v[24:27] offset:192
B_p1done:
    s_waitcnt vmcnt(0)
    v_lshlrev_b32 v96, 16, v96
    v_lshlrev_b32 v97, 16, v97
    v_lshlrev_b32 v98, 16, v98
    v_lshlrev_b32 v99, 16, v99
    v_lshlrev_b32 v100, 16, v100
    v_lshlrev_b32 v101, 16, v101
    v_lshlrev_b32 v102, 16, v102
    v_lshlrev_b32 v103, 16, v103
    v_lshlrev_b32 v104, 16, v104
    v_lshlrev_b32 v105, 16, v105
    v_lshlrev_b32 v106, 16, v106
    v_lshlrev_b32 v107, 16, v107
    v_lshlrev_b32 v108, 16, v108
    v_lshlrev_b32 v109, 16, v109
    v_lshlrev_b32 v110, 16, v110
    v_lshlrev_b32 v111, 16, v111
    s_waitcnt lgkmcnt(0)
    s_barrier
    v_mov_b32 v5, 24704
    ds_read_b32 v5, v5
    s_waitcnt lgkmcnt(0)
    v_readfirstlane_b32 s61, v5
    s_mov_b32 s62, 0
B_round:
    s_cmp_eq_u32 s62, 0
    s_cbranch_scc0 B_src_ovf
    s_mul_i32 s63, s2, 64000
    s_mov_b32 s64, 0
    s_branch B_src_done
B_src_ovf:
    s_sub_u32 s65, s62, 1
    s_lshl_b32 s66, s65, 2
    s_add_u32 s66, s66, 18874368
    v_mov_b32 v5, s66
    buffer_load_dword v5, v5, s[44:47], 0 offen
    s_waitcnt vmcnt(0)
    v_readfirstlane_b32 s64, v5
    s_cmp_eq_u32 s64, 0
    s_cbranch_scc1 B_next
    s_mul_i32 s63, s65, 20480
    s_add_u32 s63, s63, 19922944
B_src_done:
    v_cmp_gt_u32 vcc, 64, v0
    s_and_saveexec_b64 s[58:59], vcc
    v_lshlrev_b32 v5, 2, v0
    v_mov_b32 v8, 0
    ds_write_b32 v5, v8 offset:23936
    s_mov_b64 exec, s[58:59]
    s_mul_i32 s60, s2, 1000
    s_add_u32 s60, s60, 16777216
    v_add_u32 v5, 0, v0
    v_lshl_add_u32 v6, v5, 3, s63
    buffer_load_dwordx2 v[12:13], v6, s[44:47], 0 offen
    v_lshrrev_b32 v6, 5, v5
    v_lshl_add_u32 v6, v6, 2, s60
    buffer_load_dword v28, v6, s[44:47], 0 offen
    v_add_u32 v5, 1024, v0
    v_lshl_add_u32 v6, v5, 3, s63
    buffer_load_dwordx2 v[14:15], v6, s[44:47], 0 offen
    v_lshrrev_b32 v6, 5, v5
    v_lshl_add_u32 v6, v6, 2, s60
    buffer_load_dword v29, v6, s[44:47], 0 offen
    v_add_u32 v5, 2048, v0
    v_lshl_add_u32 v6, v5, 3, s63
    buffer_load_dwordx2 v[16:17], v6, s[44:47], 0 offen
    v_lshrrev_b32 v6, 5, v5
    v_lshl_add_u32 v6, v6, 2, s60
    buffer_load_dword v30, v6, s[44:47], 0 offen
    v_add_u32 v5, 3072, v0
    v_lshl_add_u32 v6, v5, 3, s63
    buffer_load_dwordx2 v[18:19], v6, s[44:47], 0 offen
    v_lshrrev_b32 v6, 5, v5
    v_lshl_add_u32 v6, v6, 2, s60
    buffer_load_dword v31, v6, s[44:47], 0 offen
    v_add_u32 v5, 4096, v0
    v_lshl_add_u32 v6, v5, 3, s63
    buffer_load_dwordx2 v[20:21], v6, s[44:47], 0 offen
    v_lshrrev_b32 v6, 5, v5
    v_lshl_add_u32 v6, v6, 2, s60
    buffer_load_dword v32, v6, s[44:47], 0 offen
    v_add_u32 v5, 5120, v0
    v_lshl_add_u32 v6, v5, 3, s63
    buffer_load_dwordx2 v[22:23], v6, s[44:47], 0 offen
    v_lshrrev_b32 v6, 5, v5
    v_lshl_add_u32 v6, v6, 2, s60
    buffer_load_dword v33, v6, s[44:47], 0 offen
    v_add_u32 v5, 6144, v0
    v_lshl_add_u32 v6, v5, 3, s63
    buffer_load_dwordx2 v[24:25], v6, s[44:47], 0 offen
    v_lshrrev_b32 v6, 5, v5
    v_lshl_add_u32 v6, v6, 2, s60
    buffer_load_dword v34, v6, s[44:47], 0 offen
    v_add_u32 v5, 7168, v0
    v_lshl_add_u32 v6, v5, 3, s63
    buffer_load_dwordx2 v[26:27], v6, s[44:47], 0 offen
    v_lshrrev_b32 v6, 5, v5
    v_lshl_add_u32 v6, v6, 2, s60
    buffer_load_dword v35, v6, s[44:47], 0 offen
    s_waitcnt lgkmcnt(0)
    s_barrier
    s_waitcnt vmcnt(0)
    s_mov_b32 s67, 52429
    s_movk_i32 s98, 8000
    s_movk_i32 s99, 2560
    v_mov_b32 v36, 252
    v_mov_b32 v37, 1
    v_add_u32 v5, 0, v0
    s_cmp_eq_u32 s62, 0
    s_cbranch_scc0 B_v0
    v_and_b32 v6, 31, v5
    v_cmp_lt_u32 vcc, v6, v28
    v_cmp_gt_u32 s[58:59], s98, v5
    s_branch B_w0
B_v0:
    v_cmp_gt_u32 vcc, s64, v5
    v_cmp_gt_u32 s[58:59], s99, v5
B_w0:
    s_and_b64 vcc, vcc, s[58:59]
    v_lshrrev_b32 v6, 16, v13
    v_mul_u32_u24 v7, s67, v6
    v_lshrrev_b32 v7, 21, v7
    v_cmp_eq_u32 s[58:59], s2, v7
    s_and_b64 vcc, vcc, s[58:59]
    v_subrev_u32 v6, s52, v6
    v_lshlrev_b32 v6, 2, v6
    s_nop 0
    v_cndmask_b32 v28, v36, v6, vcc
    ds_add_u32 v28, v37 offset:23936
    v_add_u32 v5, 1024, v0
    s_cmp_eq_u32 s62, 0
    s_cbranch_scc0 B_v1
    v_and_b32 v6, 31, v5
    v_cmp_lt_u32 vcc, v6, v29
    v_cmp_gt_u32 s[58:59], s98, v5
    s_branch B_w1
B_v1:
    v_cmp_gt_u32 vcc, s64, v5
    v_cmp_gt_u32 s[58:59], s99, v5
B_w1:
    s_and_b64 vcc, vcc, s[58:59]
    v_lshrrev_b32 v6, 16, v15
    v_mul_u32_u24 v7, s67, v6
    v_lshrrev_b32 v7, 21, v7
    v_cmp_eq_u32 s[58:59], s2, v7
    s_and_b64 vcc, vcc, s[58:59]
    v_subrev_u32 v6, s52, v6
    v_lshlrev_b32 v6, 2, v6
    s_nop 0
    v_cndmask_b32 v29, v36, v6, vcc
    ds_add_u32 v29, v37 offset:23936
    v_add_u32 v5, 2048, v0
    s_cmp_eq_u32 s62, 0
    s_cbranch_scc0 B_v2
    v_and_b32 v6, 31, v5
    v_cmp_lt_u32 vcc, v6, v30
    v_cmp_gt_u32 s[58:59], s98, v5
    s_branch B_w2
B_v2:
    v_cmp_gt_u32 vcc, s64, v5
    v_cmp_gt_u32 s[58:59], s99, v5
B_w2:
    s_and_b64 vcc, vcc, s[58:59]
    v_lshrrev_b32 v6, 16, v17
    v_mul_u32_u24 v7, s67, v6
    v_lshrrev_b32 v7, 21, v7
    v_cmp_eq_u32 s[58:59], s2, v7
    s_and_b64 vcc, vcc, s[58:59]
    v_subrev_u32 v6, s52, v6
    v_lshlrev_b32 v6, 2, v6
    s_nop 0
    v_cndmask_b32 v30, v36, v6, vcc
    ds_add_u32 v30, v37 offset:23936
    v_add_u32 v5, 3072, v0
    s_cmp_eq_u32 s62, 0
    s_cbranch_scc0 B_v3
    v_and_b32 v6, 31, v5
    v_cmp_lt_u32 vcc, v6, v31
    v_cmp_gt_u32 s[58:59], s98, v5
    s_branch B_w3
B_v3:
    v_cmp_gt_u32 vcc, s64, v5
    v_cmp_gt_u32 s[58:59], s99, v5
B_w3:
    s_and_b64 vcc, vcc, s[58:59]
    v_lshrrev_b32 v6, 16, v19
    v_mul_u32_u24 v7, s67, v6
    v_lshrrev_b32 v7, 21, v7
    v_cmp_eq_u32 s[58:59], s2, v7
    s_and_b64 vcc, vcc, s[58:59]
    v_subrev_u32 v6, s52, v6
    v_lshlrev_b32 v6, 2, v6
    s_nop 0
    v_cndmask_b32 v31, v36, v6, vcc
    ds_add_u32 v31, v37 offset:23936
    v_add_u32 v5, 4096, v0
    s_cmp_eq_u32 s62, 0
    s_cbranch_scc0 B_v4
    v_and_b32 v6, 31, v5
    v_cmp_lt_u32 vcc, v6, v32
    v_cmp_gt_u32 s[58:59], s98, v5
    s_branch B_w4
B_v4:
    v_cmp_gt_u32 vcc, s64, v5
    v_cmp_gt_u32 s[58:59], s99, v5
B_w4:
    s_and_b64 vcc, vcc, s[58:59]
    v_lshrrev_b32 v6, 16, v21
    v_mul_u32_u24 v7, s67, v6
    v_lshrrev_b32 v7, 21, v7
    v_cmp_eq_u32 s[58:59], s2, v7
    s_and_b64 vcc, vcc, s[58:59]
    v_subrev_u32 v6, s52, v6
    v_lshlrev_b32 v6, 2, v6
    s_nop 0
    v_cndmask_b32 v32, v36, v6, vcc
    ds_add_u32 v32, v37 offset:23936
    v_add_u32 v5, 5120, v0
    s_cmp_eq_u32 s62, 0
    s_cbranch_scc0 B_v5
    v_and_b32 v6, 31, v5
    v_cmp_lt_u32 vcc, v6, v33
    v_cmp_gt_u32 s[58:59], s98, v5
    s_branch B_w5
B_v5:
    v_cmp_gt_u32 vcc, s64, v5
    v_cmp_gt_u32 s[58:59], s99, v5
B_w5:
    s_and_b64 vcc, vcc, s[58:59]
    v_lshrrev_b32 v6, 16, v23
    v_mul_u32_u24 v7, s67, v6
    v_lshrrev_b32 v7, 21, v7
    v_cmp_eq_u32 s[58:59], s2, v7
    s_and_b64 vcc, vcc, s[58:59]
    v_subrev_u32 v6, s52, v6
    v_lshlrev_b32 v6, 2, v6
    s_nop 0
    v_cndmask_b32 v33, v36, v6, vcc
    ds_add_u32 v33, v37 offset:23936
    v_add_u32 v5, 6144, v0
    s_cmp_eq_u32 s62, 0
    s_cbranch_scc0 B_v6
    v_and_b32 v6, 31, v5
    v_cmp_lt_u32 vcc, v6, v34
    v_cmp_gt_u32 s[58:59], s98, v5
    s_branch B_w6
B_v6:
    v_cmp_gt_u32 vcc, s64, v5
    v_cmp_gt_u32 s[58:59], s99, v5
B_w6:
    s_and_b64 vcc, vcc, s[58:59]
    v_lshrrev_b32 v6, 16, v25
    v_mul_u32_u24 v7, s67, v6
    v_lshrrev_b32 v7, 21, v7
    v_cmp_eq_u32 s[58:59], s2, v7
    s_and_b64 vcc, vcc, s[58:59]
    v_subrev_u32 v6, s52, v6
    v_lshlrev_b32 v6, 2, v6
    s_nop 0
    v_cndmask_b32 v34, v36, v6, vcc
    ds_add_u32 v34, v37 offset:23936
    v_add_u32 v5, 7168, v0
    s_cmp_eq_u32 s62, 0
    s_cbranch_scc0 B_v7
    v_and_b32 v6, 31, v5
    v_cmp_lt_u32 vcc, v6, v35
    v_cmp_gt_u32 s[58:59], s98, v5
    s_branch B_w7
B_v7:
    v_cmp_gt_u32 vcc, s64, v5
    v_cmp_gt_u32 s[58:59], s99, v5
B_w7:
    s_and_b64 vcc, vcc, s[58:59]
    v_lshrrev_b32 v6, 16, v27
    v_mul_u32_u24 v7, s67, v6
    v_lshrrev_b32 v7, 21, v7
    v_cmp_eq_u32 s[58:59], s2, v7
    s_and_b64 vcc, vcc, s[58:59]
    v_subrev_u32 v6, s52, v6
    v_lshlrev_b32 v6, 2, v6
    s_nop 0
    v_cndmask_b32 v35, v36, v6, vcc
    ds_add_u32 v35, v37 offset:23936
    s_waitcnt lgkmcnt(0)
    s_barrier
    s_cmp_lg_u32 s3, 0
    s_cbranch_scc1 B_pfx
    v_lshlrev_b32 v5, 2, v0
    ds_read_b32 v6, v5 offset:23936
    s_waitcnt lgkmcnt(0)
    v_add_u32 v6, 15, v6
    v_and_b32 v6, 0xfffffff0, v6
    v_mov_b32 v7, v6
    s_nop 1
    v_add_u32_dpp v7, v7, v7 row_shr:1 row_mask:0xf bank_mask:0xf bound_ctrl:0
    s_nop 1
    v_add_u32_dpp v7, v7, v7 row_shr:2 row_mask:0xf bank_mask:0xf bound_ctrl:0
    s_nop 1
    v_add_u32_dpp v7, v7, v7 row_shr:4 row_mask:0xf bank_mask:0xf bound_ctrl:0
    s_nop 1
    v_add_u32_dpp v7, v7, v7 row_shr:8 row_mask:0xf bank_mask:0xf bound_ctrl:0
    s_nop 1
    v_add_u32_dpp v7, v7, v7 row_bcast:15 row_mask:0xa bank_mask:0xf
    s_nop 1
    v_add_u32_dpp v7, v7, v7 row_bcast:31 row_mask:0xc bank_mask:0xf
    v_sub_u32 v7, v7, v6
    ds_write_b32 v5, v7 offset:24192
    ds_write_b32 v5, v7 offset:24448
B_pfx:
    s_waitcnt lgkmcnt(0)
    s_barrier
    ds_add_rtn_u32 v28, v28, v37 offset:24448
    ds_add_rtn_u32 v29, v29, v37 offset:24448
    ds_add_rtn_u32 v30, v30, v37 offset:24448
    ds_add_rtn_u32 v31, v31, v37 offset:24448
    ds_add_rtn_u32 v32, v32, v37 offset:24448
    ds_add_rtn_u32 v33, v33, v37 offset:24448
    ds_add_rtn_u32 v34, v34, v37 offset:24448
    ds_add_rtn_u32 v35, v35, v37 offset:24448
    s_waitcnt lgkmcnt(0)
    v_lshlrev_b32 v28, 3, v28
    v_lshlrev_b32 v29, 3, v29
    v_lshlrev_b32 v30, 3, v30
    v_lshlrev_b32 v31, 3, v31
    v_lshlrev_b32 v32, 3, v32
    v_lshlrev_b32 v33, 3, v33
    v_lshlrev_b32 v34, 3, v34
    v_lshlrev_b32 v35, 3, v35
    ds_write_b64 v28, v[12:13] offset:37120
    ds_write_b64 v29, v[14:15] offset:37120
    ds_write_b64 v30, v[16:17] offset:37120
    ds_write_b64 v31, v[18:19] offset:37120
    ds_write_b64 v32, v[20:21] offset:37120
    ds_write_b64 v33, v[22:23] offset:37120
    ds_write_b64 v34, v[24:25] offset:37120
    ds_write_b64 v35, v[26:27] offset:37120
    s_waitcnt lgkmcnt(0)
    s_barrier
    s_mov_b32 s68, s3
B_node:
    s_cmp_ge_u32 s68, 40
    s_cbranch_scc1 B_nodes_done
    s_lshl_b32 s60, s68, 2
    v_mov_b32 v5, s60
    ds_read_b32 v6, v5 offset:23936
    ds_read_b32 v7, v5 offset:24192
    s_mul_i32 s60, s68, 272
    v_lshl_add_u32 v116, v2, 4, s60
    s_add_u32 s60, s52, s68
    s_lshl_b32 s60, s60, 4
    s_add_u32 s60, s60, 17825792
    v_mov_b32 v5, s60
    buffer_load_dwordx4 v[112:115], v5, s[44:47], 0 offen
    s_waitcnt lgkmcnt(0)
    v_readfirstlane_b32 s69, v6
    v_readfirstlane_b32 s86, v7
    v_mov_b32 v76, 0
    v_mov_b32 v77, 0
    v_mov_b32 v78, 0
    v_mov_b32 v79, 0
    v_mov_b32 v80, 0
    v_mov_b32 v81, 0
    v_mov_b32 v82, 0
    v_mov_b32 v83, 0
    v_mov_b32 v84, 0
    v_mov_b32 v85, 0
    v_mov_b32 v86, 0
    v_mov_b32 v87, 0
    v_mov_b32 v88, 0
    v_mov_b32 v89, 0
    v_mov_b32 v90, 0
    v_mov_b32 v91, 0
    v_mov_b32 v92, 0
    v_mov_b32 v93, 0
    v_mov_b32 v94, 0
    s_mov_b32 s87, 0
    s_cmp_ge_u32 s87, s69
    s_cbranch_scc1 B_tiles_done
    v_add_u32 v5, s87, v1
    v_cmp_gt_u32 s[88:89], s69, v5
    v_add_u32 v5, s86, v5
    v_lshlrev_b32 v5, 3, v5
    ds_read_b64 v[6:7], v5 offset:37120
    s_waitcnt lgkmcnt(0)
    v_and_b32 v8, 0xffff, v7
    v_and_b32 v9, 1, v2
    v_lshlrev_b32 v9, 4, v9
    v_lshl_add_u32 v9, v6, 5, v9
    buffer_load_dwordx4 v[44:47], v9, s[24:27], 0 offen
    v_lshlrev_b32 v9, 7, v8
    v_lshl_add_u32 v9, v2, 4, v9
    buffer_load_dwordx4 v[48:51], v9, s[20:23], 0 offen
    buffer_load_dwordx4 v[52:55], v9, s[20:23], 0 offen offset:64
    v_lshlrev_b32 v9, 4, v8
    v_add_u32 v9, 17825792, v9
    buffer_load_dwordx4 v[56:59], v9, s[44:47], 0 offen
B_tile:
    s_add_u32 s87, s87, 16
    s_cmp_ge_u32 s87, s69
    s_cbranch_scc1 B_lastA
    v_add_u32 v5, s87, v1
    v_cmp_gt_u32 s[90:91], s69, v5
    v_add_u32 v5, s86, v5
    v_lshlrev_b32 v5, 3, v5
    ds_read_b64 v[6:7], v5 offset:37120
    s_waitcnt lgkmcnt(0)
    v_and_b32 v8, 0xffff, v7
    v_and_b32 v9, 1, v2
    v_lshlrev_b32 v9, 4, v9
    v_lshl_add_u32 v9, v6, 5, v9
    buffer_load_dwordx4 v[60:63], v9, s[24:27], 0 offen
    v_lshlrev_b32 v9, 7, v8
    v_lshl_add_u32 v9, v2, 4, v9
    buffer_load_dwordx4 v[64:67], v9, s[20:23], 0 offen
    buffer_load_dwordx4 v[68:71], v9, s[20:23], 0 offen offset:64
    v_lshlrev_b32 v9, 4, v8
    v_add_u32 v9, 17825792, v9
    buffer_load_dwordx4 v[72:75], v9, s[44:47], 0 offen
    s_waitcnt vmcnt(4)
    ds_read_b128 v[12:15], v116 offset:0
    ds_read_b128 v[16:19], v116 offset:64
    ds_read_b128 v[20:23], v116 offset:128
    ds_read_b128 v[24:27], v116 offset:192
    ds_read_b128 v[36:39], v4 offset:24832
    ds_read_b128 v[40:43], v4 offset:28928
    v_sub_f32 v56, v112, v56
    v_cndmask_b32 v56, 0, v56, s[88:89]
    v_sub_f32 v57, v113, v57
    v_cndmask_b32 v57, 0, v57, s[88:89]
    v_sub_f32 v58, v114, v58
    v_cndmask_b32 v58, 0, v58, s[88:89]
    v_mul_f32 v10, v56, v56
    v_fmac_f32 v10, v57, v57
    v_fmac_f32 v10, v58, v58
    v_cvt_pk_bf16_f32 v10, v10, 0
    v_cndmask_b32 v44, v10, v44, s[54:55]
    v_cndmask_b32 v45, 0, v45, s[54:55]
    v_cndmask_b32 v46, 0, v46, s[54:55]
    v_cndmask_b32 v47, 0, v47, s[54:55]
    v_cndmask_b32 v44, 0, v44, s[94:95]
    v_mov_b32 v10, 0xc6ea6000
    s_waitcnt lgkmcnt(2)
    v_cndmask_b32 v12, v10, v12, s[88:89]
    v_cndmask_b32 v13, v10, v13, s[88:89]
    v_cndmask_b32 v14, v10, v14, s[88:89]
    v_cndmask_b32 v15, v10, v15, s[88:89]
    v_cndmask_b32 v16, v10, v16, s[88:89]
    v_cndmask_b32 v17, v10, v17, s[88:89]
    v_cndmask_b32 v18, v10, v18, s[88:89]
    v_cndmask_b32 v19, v10, v19, s[88:89]
    v_cndmask_b32 v20, v10, v20, s[88:89]
    v_cndmask_b32 v21, v10, v21, s[88:89]
    v_cndmask_b32 v22, v10, v22, s[88:89]
    v_cndmask_b32 v23, v10, v23, s[88:89]
    v_cndmask_b32 v24, v10, v24, s[88:89]
    v_cndmask_b32 v25, v10, v25, s[88:89]
    v_cndmask_b32 v26, v10, v26, s[88:89]
    v_cndmask_b32 v27, v10, v27, s[88:89]
    s_waitcnt lgkmcnt(1)
    v_mfma_f32_16x16x32_bf16 v[12:15], v[36:39], v[48:51], v[12:15]
    ds_read_b128 v[36:39], v4 offset:33024
    s_waitcnt lgkmcnt(1)
    v_mfma_f32_16x16x32_bf16 v[12:15], v[40:43], v[52:55], v[12:15]
    ds_read_b128 v[40:43], v4 offset:25856
    s_waitcnt lgkmcnt(1)
    v_mfma_f32_16x16x32_bf16 v[12:15], v[36:39], v[44:47], v[12:15]
    ds_read_b128 v[36:39], v4 offset:29952
    s_waitcnt lgkmcnt(1)
    v_mfma_f32_16x16x32_bf16 v[16:19], v[40:43], v[48:51], v[16:19]
    ds_read_b128 v[40:43], v4 offset:34048
    s_waitcnt lgkmcnt(1)
    v_mfma_f32_16x16x32_bf16 v[16:19], v[36:39], v[52:55], v[16:19]
    ds_read_b128 v[36:39], v4 offset:26880
    s_waitcnt lgkmcnt(1)
    v_mfma_f32_16x16x32_bf16 v[16:19], v[40:43], v[44:47], v[16:19]
    ds_read_b128 v[40:43], v4 offset:30976
    s_waitcnt lgkmcnt(1)
    v_mfma_f32_16x16x32_bf16 v[20:23], v[36:39], v[48:51], v[20:23]
    ds_read_b128 v[36:39], v4 offset:35072
    s_waitcnt lgkmcnt(1)
    v_mfma_f32_16x16x32_bf16 v[20:23], v[40:43], v[52:55], v[20:23]
    ds_read_b128 v[40:43], v4 offset:27904
    s_waitcnt lgkmcnt(1)
    v_mfma_f32_16x16x32_bf16 v[20:23], v[36:39], v[44:47], v[20:23]
    ds_read_b128 v[36:39], v4 offset:32000
    s_waitcnt lgkmcnt(1)
    v_mfma_f32_16x16x32_bf16 v[24:27], v[40:43], v[48:51], v[24:27]
    ds_read_b128 v[40:43], v4 offset:36096
    s_waitcnt lgkmcnt(1)
    v_mfma_f32_16x16x32_bf16 v[24:27], v[36:39], v[52:55], v[24:27]
    s_nop 0
    s_waitcnt lgkmcnt(0)
    v_mfma_f32_16x16x32_bf16 v[24:27], v[40:43], v[44:47], v[24:27]
    s_nop 7
    v_mov_b32 v11, 0
    v_mul_f32 v28, 0xbfb8aa3b, v12
    v_mul_f32 v29, 0xbfb8aa3b, v13
    v_mul_f32 v30, 0xbfb8aa3b, v14
    v_mul_f32 v31, 0xbfb8aa3b, v15
    v_mul_f32 v32, 0xbfb8aa3b, v16
    v_mul_f32 v33, 0xbfb8aa3b, v17
    v_mul_f32 v34, 0xbfb8aa3b, v18
    v_mul_f32 v35, 0xbfb8aa3b, v19
    v_exp_f32 v28, v28
    v_exp_f32 v29, v29
    v_exp_f32 v30, v30
    v_exp_f32 v31, v31
    v_exp_f32 v32, v32
    v_exp_f32 v33, v33
    v_exp_f32 v34, v34
    v_exp_f32 v35, v35
    v_add_f32 v28, 1.0, v28
    v_add_f32 v29, 1.0, v29
    v_add_f32 v30, 1.0, v30
    v_add_f32 v31, 1.0, v31
    v_add_f32 v32, 1.0, v32
    v_add_f32 v33, 1.0, v33
    v_add_f32 v34, 1.0, v34
    v_add_f32 v35, 1.0, v35
    v_rcp_f32 v28, v28
    v_rcp_f32 v29, v29
    v_rcp_f32 v30, v30
    v_rcp_f32 v31, v31
    v_rcp_f32 v32, v32
    v_rcp_f32 v33, v33
    v_rcp_f32 v34, v34
    v_rcp_f32 v35, v35
    v_mul_f32 v28, v12, v28
    v_mul_f32 v29, v13, v29
    v_mul_f32 v30, v14, v30
    v_mul_f32 v31, v15, v31
    v_mul_f32 v32, v16, v32
    v_mul_f32 v33, v17, v33
    v_mul_f32 v34, v18, v34
    v_mul_f32 v35, v19, v35
    v_add_f32 v76, v76, v28
    v_fmac_f32 v11, v28, v96
    v_add_f32 v77, v77, v29
    v_fmac_f32 v11, v29, v97
    v_add_f32 v78, v78, v30
    v_fmac_f32 v11, v30, v98
    v_add_f32 v79, v79, v31
    v_fmac_f32 v11, v31, v99
    v_add_f32 v80, v80, v32
    v_fmac_f32 v11, v32, v100
    v_add_f32 v81, v81, v33
    v_fmac_f32 v11, v33, v101
    v_add_f32 v82, v82, v34
    v_fmac_f32 v11, v34, v102
    v_add_f32 v83, v83, v35
    v_fmac_f32 v11, v35, v103
    v_mul_f32 v28, 0xbfb8aa3b, v20
    v_mul_f32 v29, 0xbfb8aa3b, v21
    v_mul_f32 v30, 0xbfb8aa3b, v22
    v_mul_f32 v31, 0xbfb8aa3b, v23
    v_mul_f32 v32, 0xbfb8aa3b, v24
    v_mul_f32 v33, 0xbfb8aa3b, v25
    v_mul_f32 v34, 0xbfb8aa3b, v26
    v_mul_f32 v35, 0xbfb8aa3b, v27
    v_exp_f32 v28, v28
    v_exp_f32 v29, v29
    v_exp_f32 v30, v30
    v_exp_f32 v31, v31
    v_exp_f32 v32, v32
    v_exp_f32 v33, v33
    v_exp_f32 v34, v34
    v_exp_f32 v35, v35
    v_add_f32 v28, 1.0, v28
    v_add_f32 v29, 1.0, v29
    v_add_f32 v30, 1.0, v30
    v_add_f32 v31, 1.0, v31
    v_add_f32 v32, 1.0, v32
    v_add_f32 v33, 1.0, v33
    v_add_f32 v34, 1.0, v34
    v_add_f32 v35, 1.0, v35
    v_rcp_f32 v28, v28
    v_rcp_f32 v29, v29
    v_rcp_f32 v30, v30
    v_rcp_f32 v31, v31
    v_rcp_f32 v32, v32
    v_rcp_f32 v33, v33
    v_rcp_f32 v34, v34
    v_rcp_f32 v35, v35
    v_mul_f32 v28, v20, v28
    v_mul_f32 v29, v21, v29
    v_mul_f32 v30, v22, v30
    v_mul_f32 v31, v23, v31
    v_mul_f32 v32, v24, v32
    v_mul_f32 v33, v25, v33
    v_mul_f32 v34, v26, v34
    v_mul_f32 v35, v27, v35
    v_add_f32 v84, v84, v28
    v_fmac_f32 v11, v28, v104
    v_add_f32 v85, v85, v29
    v_fmac_f32 v11, v29, v105
    v_add_f32 v86, v86, v30
    v_fmac_f32 v11, v30, v106
    v_add_f32 v87, v87, v31
    v_fmac_f32 v11, v31, v107
    v_add_f32 v88, v88, v32
    v_fmac_f32 v11, v32, v108
    v_add_f32 v89, v89, v33
    v_fmac_f32 v11, v33, v109
    v_add_f32 v90, v90, v34
    v_fmac_f32 v11, v34, v110
    v_add_f32 v91, v91, v35
    v_fmac_f32 v11, v35, v111
    v_fmac_f32 v92, v56, v11
    v_fmac_f32 v93, v57, v11
    v_fmac_f32 v94, v58, v11
    s_add_u32 s87, s87, 16
    s_cmp_ge_u32 s87, s69
    s_cbranch_scc1 B_lastB
    v_add_u32 v5, s87, v1
    v_cmp_gt_u32 s[88:89], s69, v5
    v_add_u32 v5, s86, v5
    v_lshlrev_b32 v5, 3, v5
    ds_read_b64 v[6:7], v5 offset:37120
    s_waitcnt lgkmcnt(0)
    v_and_b32 v8, 0xffff, v7
    v_and_b32 v9, 1, v2
    v_lshlrev_b32 v9, 4, v9
    v_lshl_add_u32 v9, v6, 5, v9
    buffer_load_dwordx4 v[44:47], v9, s[24:27], 0 offen
    v_lshlrev_b32 v9, 7, v8
    v_lshl_add_u32 v9, v2, 4, v9
    buffer_load_dwordx4 v[48:51], v9, s[20:23], 0 offen
    buffer_load_dwordx4 v[52:55], v9, s[20:23], 0 offen offset:64
    v_lshlrev_b32 v9, 4, v8
    v_add_u32 v9, 17825792, v9
    buffer_load_dwordx4 v[56:59], v9, s[44:47], 0 offen
    s_waitcnt vmcnt(4)
    ds_read_b128 v[12:15], v116 offset:0
    ds_read_b128 v[16:19], v116 offset:64
    ds_read_b128 v[20:23], v116 offset:128
    ds_read_b128 v[24:27], v116 offset:192
    ds_read_b128 v[36:39], v4 offset:24832
    ds_read_b128 v[40:43], v4 offset:28928
    v_sub_f32 v72, v112, v72
    v_cndmask_b32 v72, 0, v72, s[90:91]
    v_sub_f32 v73, v113, v73
    v_cndmask_b32 v73, 0, v73, s[90:91]
    v_sub_f32 v74, v114, v74
    v_cndmask_b32 v74, 0, v74, s[90:91]
    v_mul_f32 v10, v72, v72
    v_fmac_f32 v10, v73, v73
    v_fmac_f32 v10, v74, v74
    v_cvt_pk_bf16_f32 v10, v10, 0
    v_cndmask_b32 v60, v10, v60, s[54:55]
    v_cndmask_b32 v61, 0, v61, s[54:55]
    v_cndmask_b32 v62, 0, v62, s[54:55]
    v_cndmask_b32 v63, 0, v63, s[54:55]
    v_cndmask_b32 v60, 0, v60, s[94:95]
    v_mov_b32 v10, 0xc6ea6000
    s_waitcnt lgkmcnt(2)
    v_cndmask_b32 v12, v10, v12, s[90:91]
    v_cndmask_b32 v13, v10, v13, s[90:91]
    v_cndmask_b32 v14, v10, v14, s[90:91]
    v_cndmask_b32 v15, v10, v15, s[90:91]
    v_cndmask_b32 v16, v10, v16, s[90:91]
    v_cndmask_b32 v17, v10, v17, s[90:91]
    v_cndmask_b32 v18, v10, v18, s[90:91]
    v_cndmask_b32 v19, v10, v19, s[90:91]
    v_cndmask_b32 v20, v10, v20, s[90:91]
    v_cndmask_b32 v21, v10, v21, s[90:91]
    v_cndmask_b32 v22, v10, v22, s[90:91]
    v_cndmask_b32 v23, v10, v23, s[90:91]
    v_cndmask_b32 v24, v10, v24, s[90:91]
    v_cndmask_b32 v25, v10, v25, s[90:91]
    v_cndmask_b32 v26, v10, v26, s[90:91]
    v_cndmask_b32 v27, v10, v27, s[90:91]
    s_waitcnt lgkmcnt(1)
    v_mfma_f32_16x16x32_bf16 v[12:15], v[36:39], v[64:67], v[12:15]
    ds_read_b128 v[36:39], v4 offset:33024
    s_waitcnt lgkmcnt(1)
    v_mfma_f32_16x16x32_bf16 v[12:15], v[40:43], v[68:71], v[12:15]
    ds_read_b128 v[40:43], v4 offset:25856
    s_waitcnt lgkmcnt(1)
    v_mfma_f32_16x16x32_bf16 v[12:15], v[36:39], v[60:63], v[12:15]
    ds_read_b128 v[36:39], v4 offset:29952
    s_waitcnt lgkmcnt(1)
    v_mfma_f32_16x16x32_bf16 v[16:19], v[40:43], v[64:67], v[16:19]
    ds_read_b128 v[40:43], v4 offset:34048
    s_waitcnt lgkmcnt(1)
    v_mfma_f32_16x16x32_bf16 v[16:19], v[36:39], v[68:71], v[16:19]
    ds_read_b128 v[36:39], v4 offset:26880
    s_waitcnt lgkmcnt(1)
    v_mfma_f32_16x16x32_bf16 v[16:19], v[40:43], v[60:63], v[16:19]
    ds_read_b128 v[40:43], v4 offset:30976
    s_waitcnt lgkmcnt(1)
    v_mfma_f32_16x16x32_bf16 v[20:23], v[36:39], v[64:67], v[20:23]
    ds_read_b128 v[36:39], v4 offset:35072
    s_waitcnt lgkmcnt(1)
    v_mfma_f32_16x16x32_bf16 v[20:23], v[40:43], v[68:71], v[20:23]
    ds_read_b128 v[40:43], v4 offset:27904
    s_waitcnt lgkmcnt(1)
    v_mfma_f32_16x16x32_bf16 v[20:23], v[36:39], v[60:63], v[20:23]
    ds_read_b128 v[36:39], v4 offset:32000
    s_waitcnt lgkmcnt(1)
    v_mfma_f32_16x16x32_bf16 v[24:27], v[40:43], v[64:67], v[24:27]
    ds_read_b128 v[40:43], v4 offset:36096
    s_waitcnt lgkmcnt(1)
    v_mfma_f32_16x16x32_bf16 v[24:27], v[36:39], v[68:71], v[24:27]
    s_nop 0
    s_waitcnt lgkmcnt(0)
    v_mfma_f32_16x16x32_bf16 v[24:27], v[40:43], v[60:63], v[24:27]
    s_nop 7
    v_mov_b32 v11, 0
    v_mul_f32 v28, 0xbfb8aa3b, v12
    v_mul_f32 v29, 0xbfb8aa3b, v13
    v_mul_f32 v30, 0xbfb8aa3b, v14
    v_mul_f32 v31, 0xbfb8aa3b, v15
    v_mul_f32 v32, 0xbfb8aa3b, v16
    v_mul_f32 v33, 0xbfb8aa3b, v17
    v_mul_f32 v34, 0xbfb8aa3b, v18
    v_mul_f32 v35, 0xbfb8aa3b, v19
    v_exp_f32 v28, v28
    v_exp_f32 v29, v29
    v_exp_f32 v30, v30
    v_exp_f32 v31, v31
    v_exp_f32 v32, v32
    v_exp_f32 v33, v33
    v_exp_f32 v34, v34
    v_exp_f32 v35, v35
    v_add_f32 v28, 1.0, v28
    v_add_f32 v29, 1.0, v29
    v_add_f32 v30, 1.0, v30
    v_add_f32 v31, 1.0, v31
    v_add_f32 v32, 1.0, v32
    v_add_f32 v33, 1.0, v33
    v_add_f32 v34, 1.0, v34
    v_add_f32 v35, 1.0, v35
    v_rcp_f32 v28, v28
    v_rcp_f32 v29, v29
    v_rcp_f32 v30, v30
    v_rcp_f32 v31, v31
    v_rcp_f32 v32, v32
    v_rcp_f32 v33, v33
    v_rcp_f32 v34, v34
    v_rcp_f32 v35, v35
    v_mul_f32 v28, v12, v28
    v_mul_f32 v29, v13, v29
    v_mul_f32 v30, v14, v30
    v_mul_f32 v31, v15, v31
    v_mul_f32 v32, v16, v32
    v_mul_f32 v33, v17, v33
    v_mul_f32 v34, v18, v34
    v_mul_f32 v35, v19, v35
    v_add_f32 v76, v76, v28
    v_fmac_f32 v11, v28, v96
    v_add_f32 v77, v77, v29
    v_fmac_f32 v11, v29, v97
    v_add_f32 v78, v78, v30
    v_fmac_f32 v11, v30, v98
    v_add_f32 v79, v79, v31
    v_fmac_f32 v11, v31, v99
    v_add_f32 v80, v80, v32
    v_fmac_f32 v11, v32, v100
    v_add_f32 v81, v81, v33
    v_fmac_f32 v11, v33, v101
    v_add_f32 v82, v82, v34
    v_fmac_f32 v11, v34, v102
    v_add_f32 v83, v83, v35
    v_fmac_f32 v11, v35, v103
    v_mul_f32 v28, 0xbfb8aa3b, v20
    v_mul_f32 v29, 0xbfb8aa3b, v21
    v_mul_f32 v30, 0xbfb8aa3b, v22
    v_mul_f32 v31, 0xbfb8aa3b, v23
    v_mul_f32 v32, 0xbfb8aa3b, v24
    v_mul_f32 v33, 0xbfb8aa3b, v25
    v_mul_f32 v34, 0xbfb8aa3b, v26
    v_mul_f32 v35, 0xbfb8aa3b, v27
    v_exp_f32 v28, v28
    v_exp_f32 v29, v29
    v_exp_f32 v30, v30
    v_exp_f32 v31, v31
    v_exp_f32 v32, v32
    v_exp_f32 v33, v33
    v_exp_f32 v34, v34
    v_exp_f32 v35, v35
    v_add_f32 v28, 1.0, v28
    v_add_f32 v29, 1.0, v29
    v_add_f32 v30, 1.0, v30
    v_add_f32 v31, 1.0, v31
    v_add_f32 v32, 1.0, v32
    v_add_f32 v33, 1.0, v33
    v_add_f32 v34, 1.0, v34
    v_add_f32 v35, 1.0, v35
    v_rcp_f32 v28, v28
    v_rcp_f32 v29, v29
    v_rcp_f32 v30, v30
    v_rcp_f32 v31, v31
    v_rcp_f32 v32, v32
    v_rcp_f32 v33, v33
    v_rcp_f32 v34, v34
    v_rcp_f32 v35, v35
    v_mul_f32 v28, v20, v28
    v_mul_f32 v29, v21, v29
    v_mul_f32 v30, v22, v30
    v_mul_f32 v31, v23, v31
    v_mul_f32 v32, v24, v32
    v_mul_f32 v33, v25, v33
    v_mul_f32 v34, v26, v34
    v_mul_f32 v35, v27, v35
    v_add_f32 v84, v84, v28
    v_fmac_f32 v11, v28, v104
    v_add_f32 v85, v85, v29
    v_fmac_f32 v11, v29, v105
    v_add_f32 v86, v86, v30
    v_fmac_f32 v11, v30, v106
    v_add_f32 v87, v87, v31
    v_fmac_f32 v11, v31, v107
    v_add_f32 v88, v88, v32
    v_fmac_f32 v11, v32, v108
    v_add_f32 v89, v89, v33
    v_fmac_f32 v11, v33, v109
    v_add_f32 v90, v90, v34
    v_fmac_f32 v11, v34, v110
    v_add_f32 v91, v91, v35
    v_fmac_f32 v11, v35, v111
    v_fmac_f32 v92, v72, v11
    v_fmac_f32 v93, v73, v11
    v_fmac_f32 v94, v74, v11
    s_branch B_tile
B_lastA:
    s_waitcnt vmcnt(0)
    ds_read_b128 v[12:15], v116 offset:0
    ds_read_b128 v[16:19], v116 offset:64
    ds_read_b128 v[20:23], v116 offset:128
    ds_read_b128 v[24:27], v116 offset:192
    ds_read_b128 v[36:39], v4 offset:24832
    ds_read_b128 v[40:43], v4 offset:28928
    v_sub_f32 v56, v112, v56
    v_cndmask_b32 v56, 0, v56, s[88:89]
    v_sub_f32 v57, v113, v57
    v_cndmask_b32 v57, 0, v57, s[88:89]
    v_sub_f32 v58, v114, v58
    v_cndmask_b32 v58, 0, v58, s[88:89]
    v_mul_f32 v10, v56, v56
    v_fmac_f32 v10, v57, v57
    v_fmac_f32 v10, v58, v58
    v_cvt_pk_bf16_f32 v10, v10, 0
    v_cndmask_b32 v44, v10, v44, s[54:55]
    v_cndmask_b32 v45, 0, v45, s[54:55]
    v_cndmask_b32 v46, 0, v46, s[54:55]
    v_cndmask_b32 v47, 0, v47, s[54:55]
    v_cndmask_b32 v44, 0, v44, s[94:95]
    v_mov_b32 v10, 0xc6ea6000
    s_waitcnt lgkmcnt(2)
    v_cndmask_b32 v12, v10, v12, s[88:89]
    v_cndmask_b32 v13, v10, v13, s[88:89]
    v_cndmask_b32 v14, v10, v14, s[88:89]
    v_cndmask_b32 v15, v10, v15, s[88:89]
    v_cndmask_b32 v16, v10, v16, s[88:89]
    v_cndmask_b32 v17, v10, v17, s[88:89]
    v_cndmask_b32 v18, v10, v18, s[88:89]
    v_cndmask_b32 v19, v10, v19, s[88:89]
    v_cndmask_b32 v20, v10, v20, s[88:89]
    v_cndmask_b32 v21, v10, v21, s[88:89]
    v_cndmask_b32 v22, v10, v22, s[88:89]
    v_cndmask_b32 v23, v10, v23, s[88:89]
    v_cndmask_b32 v24, v10, v24, s[88:89]
    v_cndmask_b32 v25, v10, v25, s[88:89]
    v_cndmask_b32 v26, v10, v26, s[88:89]
    v_cndmask_b32 v27, v10, v27, s[88:89]
    s_waitcnt lgkmcnt(1)
    v_mfma_f32_16x16x32_bf16 v[12:15], v[36:39], v[48:51], v[12:15]
    ds_read_b128 v[36:39], v4 offset:33024
    s_waitcnt lgkmcnt(1)
    v_mfma_f32_16x16x32_bf16 v[12:15], v[40:43], v[52:55], v[12:15]
    ds_read_b128 v[40:43], v4 offset:25856
    s_waitcnt lgkmcnt(1)
    v_mfma_f32_16x16x32_bf16 v[12:15], v[36:39], v[44:47], v[12:15]
    ds_read_b128 v[36:39], v4 offset:29952
    s_waitcnt lgkmcnt(1)
    v_mfma_f32_16x16x32_bf16 v[16:19], v[40:43], v[48:51], v[16:19]
    ds_read_b128 v[40:43], v4 offset:34048
    s_waitcnt lgkmcnt(1)
    v_mfma_f32_16x16x32_bf16 v[16:19], v[36:39], v[52:55], v[16:19]
    ds_read_b128 v[36:39], v4 offset:26880
    s_waitcnt lgkmcnt(1)
    v_mfma_f32_16x16x32_bf16 v[16:19], v[40:43], v[44:47], v[16:19]
    ds_read_b128 v[40:43], v4 offset:30976
    s_waitcnt lgkmcnt(1)
    v_mfma_f32_16x16x32_bf16 v[20:23], v[36:39], v[48:51], v[20:23]
    ds_read_b128 v[36:39], v4 offset:35072
    s_waitcnt lgkmcnt(1)
    v_mfma_f32_16x16x32_bf16 v[20:23], v[40:43], v[52:55], v[20:23]
    ds_read_b128 v[40:43], v4 offset:27904
    s_waitcnt lgkmcnt(1)
    v_mfma_f32_16x16x32_bf16 v[20:23], v[36:39], v[44:47], v[20:23]
    ds_read_b128 v[36:39], v4 offset:32000
    s_waitcnt lgkmcnt(1)
    v_mfma_f32_16x16x32_bf16 v[24:27], v[40:43], v[48:51], v[24:27]
    ds_read_b128 v[40:43], v4 offset:36096
    s_waitcnt lgkmcnt(1)
    v_mfma_f32_16x16x32_bf16 v[24:27], v[36:39], v[52:55], v[24:27]
    s_nop 0
    s_waitcnt lgkmcnt(0)
    v_mfma_f32_16x16x32_bf16 v[24:27], v[40:43], v[44:47], v[24:27]
    s_nop 7
    v_mov_b32 v11, 0
    v_mul_f32 v28, 0xbfb8aa3b, v12
    v_mul_f32 v29, 0xbfb8aa3b, v13
    v_mul_f32 v30, 0xbfb8aa3b, v14
    v_mul_f32 v31, 0xbfb8aa3b, v15
    v_mul_f32 v32, 0xbfb8aa3b, v16
    v_mul_f32 v33, 0xbfb8aa3b, v17
    v_mul_f32 v34, 0xbfb8aa3b, v18
    v_mul_f32 v35, 0xbfb8aa3b, v19
    v_exp_f32 v28, v28
    v_exp_f32 v29, v29
    v_exp_f32 v30, v30
    v_exp_f32 v31, v31
    v_exp_f32 v32, v32
    v_exp_f32 v33, v33
    v_exp_f32 v34, v34
    v_exp_f32 v35, v35
    v_add_f32 v28, 1.0, v28
    v_add_f32 v29, 1.0, v29
    v_add_f32 v30, 1.0, v30
    v_add_f32 v31, 1.0, v31
    v_add_f32 v32, 1.0, v32
    v_add_f32 v33, 1.0, v33
    v_add_f32 v34, 1.0, v34
    v_add_f32 v35, 1.0, v35
    v_rcp_f32 v28, v28
    v_rcp_f32 v29, v29
    v_rcp_f32 v30, v30
    v_rcp_f32 v31, v31
    v_rcp_f32 v32, v32
    v_rcp_f32 v33, v33
    v_rcp_f32 v34, v34
    v_rcp_f32 v35, v35
    v_mul_f32 v28, v12, v28
    v_mul_f32 v29, v13, v29
    v_mul_f32 v30, v14, v30
    v_mul_f32 v31, v15, v31
    v_mul_f32 v32, v16, v32
    v_mul_f32 v33, v17, v33
    v_mul_f32 v34, v18, v34
    v_mul_f32 v35, v19, v35
    v_add_f32 v76, v76, v28
    v_fmac_f32 v11, v28, v96
    v_add_f32 v77, v77, v29
    v_fmac_f32 v11, v29, v97
    v_add_f32 v78, v78, v30
    v_fmac_f32 v11, v30, v98
    v_add_f32 v79, v79, v31
    v_fmac_f32 v11, v31, v99
    v_add_f32 v80, v80, v32
    v_fmac_f32 v11, v32, v100
    v_add_f32 v81, v81, v33
    v_fmac_f32 v11, v33, v101
    v_add_f32 v82, v82, v34
    v_fmac_f32 v11, v34, v102
    v_add_f32 v83, v83, v35
    v_fmac_f32 v11, v35, v103
    v_mul_f32 v28, 0xbfb8aa3b, v20
    v_mul_f32 v29, 0xbfb8aa3b, v21
    v_mul_f32 v30, 0xbfb8aa3b, v22
    v_mul_f32 v31, 0xbfb8aa3b, v23
    v_mul_f32 v32, 0xbfb8aa3b, v24
    v_mul_f32 v33, 0xbfb8aa3b, v25
    v_mul_f32 v34, 0xbfb8aa3b, v26
    v_mul_f32 v35, 0xbfb8aa3b, v27
    v_exp_f32 v28, v28
    v_exp_f32 v29, v29
    v_exp_f32 v30, v30
    v_exp_f32 v31, v31
    v_exp_f32 v32, v32
    v_exp_f32 v33, v33
    v_exp_f32 v34, v34
    v_exp_f32 v35, v35
    v_add_f32 v28, 1.0, v28
    v_add_f32 v29, 1.0, v29
    v_add_f32 v30, 1.0, v30
    v_add_f32 v31, 1.0, v31
    v_add_f32 v32, 1.0, v32
    v_add_f32 v33, 1.0, v33
    v_add_f32 v34, 1.0, v34
    v_add_f32 v35, 1.0, v35
    v_rcp_f32 v28, v28
    v_rcp_f32 v29, v29
    v_rcp_f32 v30, v30
    v_rcp_f32 v31, v31
    v_rcp_f32 v32, v32
    v_rcp_f32 v33, v33
    v_rcp_f32 v34, v34
    v_rcp_f32 v35, v35
    v_mul_f32 v28, v20, v28
    v_mul_f32 v29, v21, v29
    v_mul_f32 v30, v22, v30
    v_mul_f32 v31, v23, v31
    v_mul_f32 v32, v24, v32
    v_mul_f32 v33, v25, v33
    v_mul_f32 v34, v26, v34
    v_mul_f32 v35, v27, v35
    v_add_f32 v84, v84, v28
    v_fmac_f32 v11, v28, v104
    v_add_f32 v85, v85, v29
    v_fmac_f32 v11, v29, v105
    v_add_f32 v86, v86, v30
    v_fmac_f32 v11, v30, v106
    v_add_f32 v87, v87, v31
    v_fmac_f32 v11, v31, v107
    v_add_f32 v88, v88, v32
    v_fmac_f32 v11, v32, v108
    v_add_f32 v89, v89, v33
    v_fmac_f32 v11, v33, v109
    v_add_f32 v90, v90, v34
    v_fmac_f32 v11, v34, v110
    v_add_f32 v91, v91, v35
    v_fmac_f32 v11, v35, v111
    v_fmac_f32 v92, v56, v11
    v_fmac_f32 v93, v57, v11
    v_fmac_f32 v94, v58, v11
    s_branch B_tiles_done
B_lastB:
    s_waitcnt vmcnt(0)
    ds_read_b128 v[12:15], v116 offset:0
    ds_read_b128 v[16:19], v116 offset:64
    ds_read_b128 v[20:23], v116 offset:128
    ds_read_b128 v[24:27], v116 offset:192
    ds_read_b128 v[36:39], v4 offset:24832
    ds_read_b128 v[40:43], v4 offset:28928
    v_sub_f32 v72, v112, v72
    v_cndmask_b32 v72, 0, v72, s[90:91]
    v_sub_f32 v73, v113, v73
    v_cndmask_b32 v73, 0, v73, s[90:91]
    v_sub_f32 v74, v114, v74
    v_cndmask_b32 v74, 0, v74, s[90:91]
    v_mul_f32 v10, v72, v72
    v_fmac_f32 v10, v73, v73
    v_fmac_f32 v10, v74, v74
    v_cvt_pk_bf16_f32 v10, v10, 0
    v_cndmask_b32 v60, v10, v60, s[54:55]
    v_cndmask_b32 v61, 0, v61, s[54:55]
    v_cndmask_b32 v62, 0, v62, s[54:55]
    v_cndmask_b32 v63, 0, v63, s[54:55]
    v_cndmask_b32 v60, 0, v60, s[94:95]
    v_mov_b32 v10, 0xc6ea6000
    s_waitcnt lgkmcnt(2)
    v_cndmask_b32 v12, v10, v12, s[90:91]
    v_cndmask_b32 v13, v10, v13, s[90:91]
    v_cndmask_b32 v14, v10, v14, s[90:91]
    v_cndmask_b32 v15, v10, v15, s[90:91]
    v_cndmask_b32 v16, v10, v16, s[90:91]
    v_cndmask_b32 v17, v10, v17, s[90:91]
    v_cndmask_b32 v18, v10, v18, s[90:91]
    v_cndmask_b32 v19, v10, v19, s[90:91]
    v_cndmask_b32 v20, v10, v20, s[90:91]
    v_cndmask_b32 v21, v10, v21, s[90:91]
    v_cndmask_b32 v22, v10, v22, s[90:91]
    v_cndmask_b32 v23, v10, v23, s[90:91]
    v_cndmask_b32 v24, v10, v24, s[90:91]
    v_cndmask_b32 v25, v10, v25, s[90:91]
    v_cndmask_b32 v26, v10, v26, s[90:91]
    v_cndmask_b32 v27, v10, v27, s[90:91]
    s_waitcnt lgkmcnt(1)
    v_mfma_f32_16x16x32_bf16 v[12:15], v[36:39], v[64:67], v[12:15]
    ds_read_b128 v[36:39], v4 offset:33024
    s_waitcnt lgkmcnt(1)
    v_mfma_f32_16x16x32_bf16 v[12:15], v[40:43], v[68:71], v[12:15]
    ds_read_b128 v[40:43], v4 offset:25856
    s_waitcnt lgkmcnt(1)
    v_mfma_f32_16x16x32_bf16 v[12:15], v[36:39], v[60:63], v[12:15]
    ds_read_b128 v[36:39], v4 offset:29952
    s_waitcnt lgkmcnt(1)
    v_mfma_f32_16x16x32_bf16 v[16:19], v[40:43], v[64:67], v[16:19]
    ds_read_b128 v[40:43], v4 offset:34048
    s_waitcnt lgkmcnt(1)
    v_mfma_f32_16x16x32_bf16 v[16:19], v[36:39], v[68:71], v[16:19]
    ds_read_b128 v[36:39], v4 offset:26880
    s_waitcnt lgkmcnt(1)
    v_mfma_f32_16x16x32_bf16 v[16:19], v[40:43], v[60:63], v[16:19]
    ds_read_b128 v[40:43], v4 offset:30976
    s_waitcnt lgkmcnt(1)
    v_mfma_f32_16x16x32_bf16 v[20:23], v[36:39], v[64:67], v[20:23]
    ds_read_b128 v[36:39], v4 offset:35072
    s_waitcnt lgkmcnt(1)
    v_mfma_f32_16x16x32_bf16 v[20:23], v[40:43], v[68:71], v[20:23]
    ds_read_b128 v[40:43], v4 offset:27904
    s_waitcnt lgkmcnt(1)
    v_mfma_f32_16x16x32_bf16 v[20:23], v[36:39], v[60:63], v[20:23]
    ds_read_b128 v[36:39], v4 offset:32000
    s_waitcnt lgkmcnt(1)
    v_mfma_f32_16x16x32_bf16 v[24:27], v[40:43], v[64:67], v[24:27]
    ds_read_b128 v[40:43], v4 offset:36096
    s_waitcnt lgkmcnt(1)
    v_mfma_f32_16x16x32_bf16 v[24:27], v[36:39], v[68:71], v[24:27]
    s_nop 0
    s_waitcnt lgkmcnt(0)
    v_mfma_f32_16x16x32_bf16 v[24:27], v[40:43], v[60:63], v[24:27]
    s_nop 7
    v_mov_b32 v11, 0
    v_mul_f32 v28, 0xbfb8aa3b, v12
    v_mul_f32 v29, 0xbfb8aa3b, v13
    v_mul_f32 v30, 0xbfb8aa3b, v14
    v_mul_f32 v31, 0xbfb8aa3b, v15
    v_mul_f32 v32, 0xbfb8aa3b, v16
    v_mul_f32 v33, 0xbfb8aa3b, v17
    v_mul_f32 v34, 0xbfb8aa3b, v18
    v_mul_f32 v35, 0xbfb8aa3b, v19
    v_exp_f32 v28, v28
    v_exp_f32 v29, v29
    v_exp_f32 v30, v30
    v_exp_f32 v31, v31
    v_exp_f32 v32, v32
    v_exp_f32 v33, v33
    v_exp_f32 v34, v34
    v_exp_f32 v35, v35
    v_add_f32 v28, 1.0, v28
    v_add_f32 v29, 1.0, v29
    v_add_f32 v30, 1.0, v30
    v_add_f32 v31, 1.0, v31
    v_add_f32 v32, 1.0, v32
    v_add_f32 v33, 1.0, v33
    v_add_f32 v34, 1.0, v34
    v_add_f32 v35, 1.0, v35
    v_rcp_f32 v28, v28
    v_rcp_f32 v29, v29
    v_rcp_f32 v30, v30
    v_rcp_f32 v31, v31
    v_rcp_f32 v32, v32
    v_rcp_f32 v33, v33
    v_rcp_f32 v34, v34
    v_rcp_f32 v35, v35
    v_mul_f32 v28, v12, v28
    v_mul_f32 v29, v13, v29
    v_mul_f32 v30, v14, v30
    v_mul_f32 v31, v15, v31
    v_mul_f32 v32, v16, v32
    v_mul_f32 v33, v17, v33
    v_mul_f32 v34, v18, v34
    v_mul_f32 v35, v19, v35
    v_add_f32 v76, v76, v28
    v_fmac_f32 v11, v28, v96
    v_add_f32 v77, v77, v29
    v_fmac_f32 v11, v29, v97
    v_add_f32 v78, v78, v30
    v_fmac_f32 v11, v30, v98
    v_add_f32 v79, v79, v31
    v_fmac_f32 v11, v31, v99
    v_add_f32 v80, v80, v32
    v_fmac_f32 v11, v32, v100
    v_add_f32 v81, v81, v33
    v_fmac_f32 v11, v33, v101
    v_add_f32 v82, v82, v34
    v_fmac_f32 v11, v34, v102
    v_add_f32 v83, v83, v35
    v_fmac_f32 v11, v35, v103
    v_mul_f32 v28, 0xbfb8aa3b, v20
    v_mul_f32 v29, 0xbfb8aa3b, v21
    v_mul_f32 v30, 0xbfb8aa3b, v22
    v_mul_f32 v31, 0xbfb8aa3b, v23
    v_mul_f32 v32, 0xbfb8aa3b, v24
    v_mul_f32 v33, 0xbfb8aa3b, v25
    v_mul_f32 v34, 0xbfb8aa3b, v26
    v_mul_f32 v35, 0xbfb8aa3b, v27
    v_exp_f32 v28, v28
    v_exp_f32 v29, v29
    v_exp_f32 v30, v30
    v_exp_f32 v31, v31
    v_exp_f32 v32, v32
    v_exp_f32 v33, v33
    v_exp_f32 v34, v34
    v_exp_f32 v35, v35
    v_add_f32 v28, 1.0, v28
    v_add_f32 v29, 1.0, v29
    v_add_f32 v30, 1.0, v30
    v_add_f32 v31, 1.0, v31
    v_add_f32 v32, 1.0, v32
    v_add_f32 v33, 1.0, v33
    v_add_f32 v34, 1.0, v34
    v_add_f32 v35, 1.0, v35
    v_rcp_f32 v28, v28
    v_rcp_f32 v29, v29
    v_rcp_f32 v30, v30
    v_rcp_f32 v31, v31
    v_rcp_f32 v32, v32
    v_rcp_f32 v33, v33
    v_rcp_f32 v34, v34
    v_rcp_f32 v35, v35
    v_mul_f32 v28, v20, v28
    v_mul_f32 v29, v21, v29
    v_mul_f32 v30, v22, v30
    v_mul_f32 v31, v23, v31
    v_mul_f32 v32, v24, v32
    v_mul_f32 v33, v25, v33
    v_mul_f32 v34, v26, v34
    v_mul_f32 v35, v27, v35
    v_add_f32 v84, v84, v28
    v_fmac_f32 v11, v28, v104
    v_add_f32 v85, v85, v29
    v_fmac_f32 v11, v29, v105
    v_add_f32 v86, v86, v30
    v_fmac_f32 v11, v30, v106
    v_add_f32 v87, v87, v31
    v_fmac_f32 v11, v31, v107
    v_add_f32 v88, v88, v32
    v_fmac_f32 v11, v32, v108
    v_add_f32 v89, v89, v33
    v_fmac_f32 v11, v33, v109
    v_add_f32 v90, v90, v34
    v_fmac_f32 v11, v34, v110
    v_add_f32 v91, v91, v35
    v_fmac_f32 v11, v35, v111
    v_fmac_f32 v92, v72, v11
    v_fmac_f32 v93, v73, v11
    v_fmac_f32 v94, v74, v11
B_tiles_done:
    s_waitcnt vmcnt(0)
    v_add_f32_dpp v76, v76, v76 row_shr:1 row_mask:0xf bank_mask:0xf bound_ctrl:0
    v_add_f32_dpp v77, v77, v77 row_shr:1 row_mask:0xf bank_mask:0xf bound_ctrl:0
    v_add_f32_dpp v78, v78, v78 row_shr:1 row_mask:0xf bank_mask:0xf bound_ctrl:0
    v_add_f32_dpp v79, v79, v79 row_shr:1 row_mask:0xf bank_mask:0xf bound_ctrl:0
    v_add_f32_dpp v80, v80, v80 row_shr:1 row_mask:0xf bank_mask:0xf bound_ctrl:0
    v_add_f32_dpp v81, v81, v81 row_shr:1 row_mask:0xf bank_mask:0xf bound_ctrl:0
    v_add_f32_dpp v82, v82, v82 row_shr:1 row_mask:0xf bank_mask:0xf bound_ctrl:0
    v_add_f32_dpp v83, v83, v83 row_shr:1 row_mask:0xf bank_mask:0xf bound_ctrl:0
    v_add_f32_dpp v84, v84, v84 row_shr:1 row_mask:0xf bank_mask:0xf bound_ctrl:0
    v_add_f32_dpp v85, v85, v85 row_shr:1 row_mask:0xf bank_mask:0xf bound_ctrl:0
    v_add_f32_dpp v86, v86, v86 row_shr:1 row_mask:0xf bank_mask:0xf bound_ctrl:0
    v_add_f32_dpp v87, v87, v87 row_shr:1 row_mask:0xf bank_mask:0xf bound_ctrl:0
    v_add_f32_dpp v88, v88, v88 row_shr:1 row_mask:0xf bank_mask:0xf bound_ctrl:0
    v_add_f32_dpp v89, v89, v89 row_shr:1 row_mask:0xf bank_mask:0xf bound_ctrl:0
    v_add_f32_dpp v90, v90, v90 row_shr:1 row_mask:0xf bank_mask:0xf bound_ctrl:0
    v_add_f32_dpp v91, v91, v91 row_shr:1 row_mask:0xf bank_mask:0xf bound_ctrl:0
    v_add_f32_dpp v92, v92, v92 row_shr:1 row_mask:0xf bank_mask:0xf bound_ctrl:0
    v_add_f32_dpp v93, v93, v93 row_shr:1 row_mask:0xf bank_mask:0xf bound_ctrl:0
    v_add_f32_dpp v94, v94, v94 row_shr:1 row_mask:0xf bank_mask:0xf bound_ctrl:0
    s_nop 1
    v_add_f32_dpp v76, v76, v76 row_shr:2 row_mask:0xf bank_mask:0xf bound_ctrl:0
    v_add_f32_dpp v77, v77, v77 row_shr:2 row_mask:0xf bank_mask:0xf bound_ctrl:0
    v_add_f32_dpp v78, v78, v78 row_shr:2 row_mask:0xf bank_mask:0xf bound_ctrl:0
    v_add_f32_dpp v79, v79, v79 row_shr:2 row_mask:0xf bank_mask:0xf bound_ctrl:0
    v_add_f32_dpp v80, v80, v80 row_shr:2 row_mask:0xf bank_mask:0xf bound_ctrl:0
    v_add_f32_dpp v81, v81, v81 row_shr:2 row_mask:0xf bank_mask:0xf bound_ctrl:0
    v_add_f32_dpp v82, v82, v82 row_shr:2 row_mask:0xf bank_mask:0xf bound_ctrl:0
    v_add_f32_dpp v83, v83, v83 row_shr:2 row_mask:0xf bank_mask:0xf bound_ctrl:0
    v_add_f32_dpp v84, v84, v84 row_shr:2 row_mask:0xf bank_mask:0xf bound_ctrl:0
    v_add_f32_dpp v85, v85, v85 row_shr:2 row_mask:0xf bank_mask:0xf bound_ctrl:0
    v_add_f32_dpp v86, v86, v86 row_shr:2 row_mask:0xf bank_mask:0xf bound_ctrl:0
    v_add_f32_dpp v87, v87, v87 row_shr:2 row_mask:0xf bank_mask:0xf bound_ctrl:0
    v_add_f32_dpp v88, v88, v88 row_shr:2 row_mask:0xf bank_mask:0xf bound_ctrl:0
    v_add_f32_dpp v89, v89, v89 row_shr:2 row_mask:0xf bank_mask:0xf bound_ctrl:0
    v_add_f32_dpp v90, v90, v90 row_shr:2 row_mask:0xf bank_mask:0xf bound_ctrl:0
    v_add_f32_dpp v91, v91, v91 row_shr:2 row_mask:0xf bank_mask:0xf bound_ctrl:0
    v_add_f32_dpp v92, v92, v92 row_shr:2 row_mask:0xf bank_mask:0xf bound_ctrl:0
    v_add_f32_dpp v93, v93, v93 row_shr:2 row_mask:0xf bank_mask:0xf bound_ctrl:0
    v_add_f32_dpp v94, v94, v94 row_shr:2 row_mask:0xf bank_mask:0xf bound_ctrl:0
    s_nop 1
    v_add_f32_dpp v76, v76, v76 row_shr:4 row_mask:0xf bank_mask:0xf bound_ctrl:0
    v_add_f32_dpp v77, v77, v77 row_shr:4 row_mask:0xf bank_mask:0xf bound_ctrl:0
    v_add_f32_dpp v78, v78, v78 row_shr:4 row_mask:0xf bank_mask:0xf bound_ctrl:0
    v_add_f32_dpp v79, v79, v79 row_shr:4 row_mask:0xf bank_mask:0xf bound_ctrl:0
    v_add_f32_dpp v80, v80, v80 row_shr:4 row_mask:0xf bank_mask:0xf bound_ctrl:0
    v_add_f32_dpp v81, v81, v81 row_shr:4 row_mask:0xf bank_mask:0xf bound_ctrl:0
    v_add_f32_dpp v82, v82, v82 row_shr:4 row_mask:0xf bank_mask:0xf bound_ctrl:0
    v_add_f32_dpp v83, v83, v83 row_shr:4 row_mask:0xf bank_mask:0xf bound_ctrl:0
    v_add_f32_dpp v84, v84, v84 row_shr:4 row_mask:0xf bank_mask:0xf bound_ctrl:0
    v_add_f32_dpp v85, v85, v85 row_shr:4 row_mask:0xf bank_mask:0xf bound_ctrl:0
    v_add_f32_dpp v86, v86, v86 row_shr:4 row_mask:0xf bank_mask:0xf bound_ctrl:0
    v_add_f32_dpp v87, v87, v87 row_shr:4 row_mask:0xf bank_mask:0xf bound_ctrl:0
    v_add_f32_dpp v88, v88, v88 row_shr:4 row_mask:0xf bank_mask:0xf bound_ctrl:0
    v_add_f32_dpp v89, v89, v89 row_shr:4 row_mask:0xf bank_mask:0xf bound_ctrl:0
    v_add_f32_dpp v90, v90, v90 row_shr:4 row_mask:0xf bank_mask:0xf bound_ctrl:0
    v_add_f32_dpp v91, v91, v91 row_shr:4 row_mask:0xf bank_mask:0xf bound_ctrl:0
    v_add_f32_dpp v92, v92, v92 row_shr:4 row_mask:0xf bank_mask:0xf bound_ctrl:0
    v_add_f32_dpp v93, v93, v93 row_shr:4 row_mask:0xf bank_mask:0xf bound_ctrl:0
    v_add_f32_dpp v94, v94, v94 row_shr:4 row_mask:0xf bank_mask:0xf bound_ctrl:0
    s_nop 1
    v_add_f32_dpp v76, v76, v76 row_shr:8 row_mask:0xf bank_mask:0xf bound_ctrl:0
    v_add_f32_dpp v77, v77, v77 row_shr:8 row_mask:0xf bank_mask:0xf bound_ctrl:0
    v_add_f32_dpp v78, v78, v78 row_shr:8 row_mask:0xf bank_mask:0xf bound_ctrl:0
    v_add_f32_dpp v79, v79, v79 row_shr:8 row_mask:0xf bank_mask:0xf bound_ctrl:0
    v_add_f32_dpp v80, v80, v80 row_shr:8 row_mask:0xf bank_mask:0xf bound_ctrl:0
    v_add_f32_dpp v81, v81, v81 row_shr:8 row_mask:0xf bank_mask:0xf bound_ctrl:0
    v_add_f32_dpp v82, v82, v82 row_shr:8 row_mask:0xf bank_mask:0xf bound_ctrl:0
    v_add_f32_dpp v83, v83, v83 row_shr:8 row_mask:0xf bank_mask:0xf bound_ctrl:0
    v_add_f32_dpp v84, v84, v84 row_shr:8 row_mask:0xf bank_mask:0xf bound_ctrl:0
    v_add_f32_dpp v85, v85, v85 row_shr:8 row_mask:0xf bank_mask:0xf bound_ctrl:0
    v_add_f32_dpp v86, v86, v86 row_shr:8 row_mask:0xf bank_mask:0xf bound_ctrl:0
    v_add_f32_dpp v87, v87, v87 row_shr:8 row_mask:0xf bank_mask:0xf bound_ctrl:0
    v_add_f32_dpp v88, v88, v88 row_shr:8 row_mask:0xf bank_mask:0xf bound_ctrl:0
    v_add_f32_dpp v89, v89, v89 row_shr:8 row_mask:0xf bank_mask:0xf bound_ctrl:0
    v_add_f32_dpp v90, v90, v90 row_shr:8 row_mask:0xf bank_mask:0xf bound_ctrl:0
    v_add_f32_dpp v91, v91, v91 row_shr:8 row_mask:0xf bank_mask:0xf bound_ctrl:0
    v_add_f32_dpp v92, v92, v92 row_shr:8 row_mask:0xf bank_mask:0xf bound_ctrl:0
    v_add_f32_dpp v93, v93, v93 row_shr:8 row_mask:0xf bank_mask:0xf bound_ctrl:0
    v_add_f32_dpp v94, v94, v94 row_shr:8 row_mask:0xf bank_mask:0xf bound_ctrl:0
    s_nop 1
    v_cmp_eq_u32 vcc, 15, v1
    s_and_saveexec_b64 s[58:59], vcc
    ds_add_f32 v116, v76 offset:13056
    ds_add_f32 v116, v77 offset:13060
    ds_add_f32 v116, v78 offset:13064
    ds_add_f32 v116, v79 offset:13068
    ds_add_f32 v116, v80 offset:13120
    ds_add_f32 v116, v81 offset:13124
    ds_add_f32 v116, v82 offset:13128
    ds_add_f32 v116, v83 offset:13132
    ds_add_f32 v116, v84 offset:13184
    ds_add_f32 v116, v85 offset:13188
    ds_add_f32 v116, v86 offset:13192
    ds_add_f32 v116, v87 offset:13196
    ds_add_f32 v116, v88 offset:13248
    ds_add_f32 v116, v89 offset:13252
    ds_add_f32 v116, v90 offset:13256
    ds_add_f32 v116, v91 offset:13260
    s_mul_i32 s60, s68, 272
    v_mov_b32 v5, s60
    ds_add_f32 v5, v92 offset:13312
    ds_add_f32 v5, v93 offset:13316
    ds_add_f32 v5, v94 offset:13320
    s_mov_b64 exec, s[58:59]
    s_add_u32 s68, s68, 16
    s_branch B_node
B_nodes_done:
    s_waitcnt lgkmcnt(0)
    s_barrier
B_next:
    s_cmp_eq_u32 s61, 0
    s_cbranch_scc1 B_final
    s_add_u32 s62, s62, 1
    s_cmp_le_u32 s62, 250
    s_cbranch_scc1 B_round
B_final:
    s_cmp_gt_u32 s3, 11
    s_cbranch_scc1 B_pos
    s_mul_i32 s70, s3, 43
    s_lshr_b32 s70, s70, 7
    s_mul_i32 s71, s70, 3
    s_sub_u32 s71, s3, s71
    s_lshl_b32 s60, s71, 4
    v_add_u32 v6, s60, v1
    v_add_u32 v7, s52, v6
    v_lshlrev_b32 v7, 7, v7
    v_lshl_add_u32 v8, v2, 4, v7
    buffer_load_dwordx4 v[16:19], v8, s[20:23], 0 offen
    buffer_load_dwordx4 v[20:23], v8, s[20:23], 0 offen offset:64
    s_lshl_b32 s72, s70, 12
    s_add_u32 s72, s72, 25186304
    buffer_load_dwordx4 v[60:63], v4, s[44:47], s72 offen offset:0
    buffer_load_dwordx4 v[64:67], v4, s[44:47], s72 offen offset:1024
    buffer_load_dwordx4 v[68:71], v4, s[44:47], s72 offen offset:2048
    buffer_load_dwordx4 v[72:75], v4, s[44:47], s72 offen offset:3072
    s_lshl_b32 s73, s70, 5
    v_lshl_add_u32 v10, v2, 3, v7
    v_add_u32 v10, s73, v10
    buffer_load_dwordx2 v[52:53], v10, s[20:23], 0 offen
    v_mul_u32_u24 v9, 272, v6
    v_lshl_add_u32 v9, v2, 5, v9
    ds_read_b128 v[32:35], v9 offset:13056
    ds_read_b128 v[36:39], v9 offset:13072
    ds_read_b128 v[40:43], v9 offset:13184
    ds_read_b128 v[44:47], v9 offset:13200
    s_waitcnt lgkmcnt(0)
    v_cvt_pk_bf16_f32 v24, v32, v33
    v_cvt_pk_bf16_f32 v25, v34, v35
    v_cvt_pk_bf16_f32 v26, v36, v37
    v_cvt_pk_bf16_f32 v27, v38, v39
    v_cvt_pk_bf16_f32 v28, v40, v41
    v_cvt_pk_bf16_f32 v29, v42, v43
    v_cvt_pk_bf16_f32 v30, v44, v45
    v_cvt_pk_bf16_f32 v31, v46, v47
    s_waitcnt vmcnt(0)
    v_mfma_f32_16x16x32_bf16 v[48:51], v[60:63], v[16:19], 0
    v_mfma_f32_16x16x32_bf16 v[48:51], v[64:67], v[20:23], v[48:51]
    v_mfma_f32_16x16x32_bf16 v[48:51], v[68:71], v[24:27], v[48:51]
    v_mfma_f32_16x16x32_bf16 v[48:51], v[72:75], v[28:31], v[48:51]
    s_nop 9
    v_mul_f32 v54, 0xbfb8aa3b, v48
    v_exp_f32 v54, v54
    s_nop 0
    v_add_f32 v54, 1.0, v54
    v_rcp_f32 v54, v54
    s_nop 0
    v_mul_f32 v54, v48, v54
    v_cvt_pk_bf16_f32 v54, v54, 0
    v_lshlrev_b32 v54, 16, v54
    v_lshlrev_b32 v55, 16, v52
    v_add_f32 v48, v54, v55
    v_mul_f32 v54, 0xbfb8aa3b, v49
    v_exp_f32 v54, v54
    s_nop 0
    v_add_f32 v54, 1.0, v54
    v_rcp_f32 v54, v54
    s_nop 0
    v_mul_f32 v54, v49, v54
    v_cvt_pk_bf16_f32 v54, v54, 0
    v_lshlrev_b32 v54, 16, v54
    v_and_b32 v55, 0xffff0000, v52
    v_add_f32 v49, v54, v55
    v_mul_f32 v54, 0xbfb8aa3b, v50
    v_exp_f32 v54, v54
    s_nop 0
    v_add_f32 v54, 1.0, v54
    v_rcp_f32 v54, v54
    s_nop 0
    v_mul_f32 v54, v50, v54
    v_cvt_pk_bf16_f32 v54, v54, 0
    v_lshlrev_b32 v54, 16, v54
    v_lshlrev_b32 v55, 16, v53
    v_add_f32 v50, v54, v55
    v_mul_f32 v54, 0xbfb8aa3b, v51
    v_exp_f32 v54, v54
    s_nop 0
    v_add_f32 v54, 1.0, v54
    v_rcp_f32 v54, v54
    s_nop 0
    v_mul_f32 v54, v51, v54
    v_cvt_pk_bf16_f32 v54, v54, 0
    v_lshlrev_b32 v54, 16, v54
    v_and_b32 v55, 0xffff0000, v53
    v_add_f32 v51, v54, v55
    v_cvt_pk_bf16_f32 v48, v48, v49
    v_cvt_pk_bf16_f32 v49, v50, v51
    v_cmp_gt_u32 vcc, 40, v6
    s_and_saveexec_b64 s[58:59], vcc
    buffer_store_dwordx2 v[48:49], v10, s[40:43], 0 offen
    s_mov_b64 exec, s[58:59]
B_pos:
    v_cmp_gt_u32 vcc, 40, v0
    s_and_saveexec_b64 s[58:59], vcc
    v_add_u32 v5, s52, v0
    v_mul_u32_u24 v6, 6, v5
    v_mul_u32_u24 v7, 272, v0
    buffer_load_ushort v8, v6, s[48:51], 0 offen offset:0
    ds_read_b32 v12, v7 offset:13312
    buffer_load_ushort v9, v6, s[48:51], 0 offen offset:2
    ds_read_b32 v13, v7 offset:13316
    buffer_load_ushort v10, v6, s[48:51], 0 offen offset:4
    ds_read_b32 v14, v7 offset:13320
    s_waitcnt vmcnt(0) lgkmcnt(0)
    v_lshlrev_b32 v8, 16, v8
    v_add_f32 v8, v8, v12
    v_cvt_pk_bf16_f32 v8, v8, 0
    v_add_u32 v15, 1280000, v6
    buffer_store_short v8, v15, s[40:43], 0 offen
    v_lshlrev_b32 v9, 16, v9
    v_add_f32 v9, v9, v13
    v_cvt_pk_bf16_f32 v9, v9, 0
    v_add_u32 v15, 1280002, v6
    buffer_store_short v9, v15, s[40:43], 0 offen
    v_lshlrev_b32 v10, 16, v10
    v_add_f32 v10, v10, v14
    v_cvt_pk_bf16_f32 v10, v10, 0
    v_add_u32 v15, 1280004, v6
    buffer_store_short v10, v15, s[40:43], 0 offen
B_done:
    s_endpgm
.section .rodata,"a"
.p2align 6
.amdhsa_kernel egnn_bin_kernel
  .amdhsa_next_free_vgpr 32
  .amdhsa_next_free_sgpr 102
  .amdhsa_accum_offset 32
  .amdhsa_group_segment_fixed_size 0
  .amdhsa_kernarg_size 88
  .amdhsa_user_sgpr_count 2
  .amdhsa_user_sgpr_kernarg_segment_ptr 1
  .amdhsa_system_sgpr_workgroup_id_x 1
.end_amdhsa_kernel
.section .rodata,"a"
.p2align 6
.amdhsa_kernel gather_scatter__cheap_equivariant_egnn__graph_kernel
  .amdhsa_next_free_vgpr 120
  .amdhsa_next_free_sgpr 102
  .amdhsa_accum_offset 120
  .amdhsa_group_segment_fixed_size 0
  .amdhsa_kernarg_size 88
  .amdhsa_user_sgpr_count 2
  .amdhsa_user_sgpr_kernarg_segment_ptr 1
  .amdhsa_system_sgpr_workgroup_id_x 1
.end_amdhsa_kernel
```
